```python
import torch

def _softmax(x, axis=-1):
    return torch.softmax(x, dim=axis)
def _gelu(x):
    return torch.nn.functional.gelu(x, approximate="tanh")
def _silu(x):
    return torch.nn.functional.silu(x)
def _sigmoid(x):
    return torch.sigmoid(x)
def _layernorm(x, axis=-1, eps=1e-5):
    m = x.mean(dim=axis, keepdim=True)
    v = x.var(dim=axis, keepdim=True, unbiased=False)
    return (x - m) / torch.sqrt(v + eps)
def _scatter_add(tgt, idx, src, axis=0):
    return tgt.clone().index_add_(axis, idx, src)
def _segment_sum(src, seg, n):
    out = torch.zeros((n,) + src.shape[1:], dtype=src.dtype)
    return out.index_add_(0, seg, src)
def _pad(x, pw):
    flat = tuple(v for pair in reversed(pw) for v in pair)
    return torch.nn.functional.pad(x, flat)

kernel_name = 'parallel_sum__compressed_kv_cla__dense_activation_silu__decode'

def setup_inputs():

    _w = (lambda a: (lambda t: t.to(torch.bfloat16) if t.is_floating_point() else t)(torch.as_tensor(a)))
    def _A_setup():
        B, H, Sq, Sk, D, M = 2, 32, 1, 4096, 128, 512
        Dc = 4 * D
        return {
            "x": _w((lambda *s: torch.randn(*s, dtype=torch.bfloat16) * 0.05)(B, Sq, M)),
            "c_kv": _w((lambda *s: torch.randn(*s, dtype=torch.bfloat16) * 0.8)(B, Sk, Dc)),
            "w_q": _w((lambda *s: torch.randn(*s, dtype=torch.bfloat16) * 3.2)(M, H, D) * (M ** -0.5)),
            "w_uk": _w((lambda *s: torch.randn(*s, dtype=torch.bfloat16) * 3.2)(Dc, H, D) * (Dc ** -0.5)),
            "w_uv": _w((lambda *s: torch.randn(*s, dtype=torch.bfloat16) * 0.8)(Dc, H, D) * (Dc ** -0.5)),
            "w_o": _w((lambda *s: torch.randn(*s, dtype=torch.bfloat16) * 0.8)(H, D, M) * ((H * D) ** -0.5)),
        }
    _A_in = _A_setup()

    def _B_setup():
        B, S, D, F = 2, 1, 512, 1376
        return {
            "x": _w((lambda *s: torch.randn(*s, dtype=torch.bfloat16) * 0.05)(B, S, D)),
            "w1": _w((lambda *s: torch.randn(*s, dtype=torch.bfloat16) * 3.2)(D, F) * (D ** -0.5)),
            "w2": _w((lambda *s: torch.randn(*s, dtype=torch.bfloat16) * 0.2)(F, D) * (F ** -0.5)),
        }
    _B_in = _B_setup()

    return {
        "A_x": _A_in["x"],
        "A_c_kv": _A_in["c_kv"],
        "A_w_q": _A_in["w_q"],
        "A_w_uk": _A_in["w_uk"],
        "A_w_uv": _A_in["w_uv"],
        "A_w_o": _A_in["w_o"],
        "B_x": _B_in["x"],
        "B_w1": _B_in["w1"],
        "B_w2": _B_in["w2"],
    }

def reference(A_x, A_c_kv, A_w_q, A_w_uk, A_w_uv, A_w_o, B_x, B_w1, B_w2):
    def _A_ref(x, c_kv, w_q, w_uk, w_uv, w_o):
        B, Sq, M = x.shape[0], x.shape[1], x.shape[2]
        Sk = c_kv.shape[1]
        H, D = w_q.shape[1], w_q.shape[2]
        q = torch.einsum("bqm,mhd->bhqd", x, w_q)
        k = torch.einsum("bkc,chd->bhkd", c_kv, w_uk)
        v = torch.einsum("bkc,chd->bhkd", c_kv, w_uv)
        scores = torch.einsum("bhqd,bhkd->bhqk", q, k) * (D ** -0.5)
        off = Sk - Sq
        qi = torch.arange(Sq)[:, None]
        kj = torch.arange(Sk)[None, :]
        cmask = kj <= (qi + off)
        scores = torch.where(cmask[None, None], scores, -1e9)
        p = _softmax(scores, axis=-1)
        ctx = torch.einsum("bhqk,bhkd->bhqd", p, v)
        return torch.einsum("bhqd,hdm->bqm", ctx, w_o)

    def _B_ref(x, w1, w2):
        h = torch.einsum("bsd,df->bsf", x, w1)
        h = _silu(h)
        out = torch.einsum("bsf,fd->bsd", h, w2)
        return out

    x = A_x
    xn = _layernorm(x, axis=-1)
    return x + _A_ref(xn, A_c_kv, A_w_q, A_w_uk, A_w_uv, A_w_o) + _B_ref(xn, B_w1, B_w2)
```

```asm
; @launch grid=(256,1,1) block=(256,1,1) lds=152576
.amdgcn_target "amdgcn-amd-amdhsa--gfx950"
.set HINT_LIMIT, 40
.text
.globl parallel_sum__compressed_kv_cla__dense_activation_silu__decode_kernel
.p2align 8
.type parallel_sum__compressed_kv_cla__dense_activation_silu__decode_kernel,@function
parallel_sum__compressed_kv_cla__dense_activation_silu__decode_kernel:
    s_load_dwordx2 s[16:17], s[0:1], 16
    s_load_dwordx2 s[48:49], s[0:1], 8
    s_load_dwordx2 s[20:21], s[0:1], 24
    s_load_dwordx2 s[12:13], s[0:1], 0
    s_load_dwordx2 s[8:9], s[0:1], 88
    s_cmp_ge_u32 s2, 256
    s_cbranch_scc1 L_end
    v_lshrrev_b32 v2, 6, v0
    v_and_b32 v1, 63, v0
    s_lshr_b32 s4, s2, 3
    v_readfirstlane_b32 s3, v2
    s_and_b32 s5, s2, 7
    v_lshlrev_b32 v4, 4, v1
    s_cmp_ge_u32 s4, 16
    s_cbranch_scc1 L_A
    v_and_b32 v5, 15, v1
    v_lshrrev_b32 v6, 4, v1
    v_lshlrev_b32 v2, 1, v6
    v_xor_b32 v2, v2, v5
    v_lshlrev_b32 v2, 4, v2
    v_lshl_add_u32 v7, v6, 13, v2
    v_xor_b32 v8, 0x80, v7
    v_add_u32 v11, 31744, v7
    v_add_u32 v12, 63488, v8
    v_add_u32 v13, 95232, v8
    s_mov_b32 s18, 4194304
    s_mov_b32 s19, 0x20000
    s_mov_b32 s14, 2048
    s_mov_b32 s15, 0x20000
    s_mov_b32 s10, 5242880
    s_mov_b32 s11, 0x20000
    v_mov_b32 v20, -1
    v_mov_b32 v21, -1
    v_mov_b32 v22, -1
    v_mov_b32 v23, -1
    v_lshrrev_b32 v3, 3, v1
    v_lshlrev_b32 v3, 10, v3
    v_and_b32 v2, 4, v1
    v_lshl_add_u32 v3, v2, 13, v3
    v_and_b32 v2, 3, v1
    v_lshl_add_u32 v3, v2, 4, v3
    s_lshr_b32 s6, s4, 2
    s_lshl2_add_u32 s6, s5, s6
    s_and_b32 s7, s4, 3
    s_lshl2_add_u32 s61, s7, s3
    s_lshl_b32 s61, s61, 18
    s_lshl_b32 s59, s6, 8
    s_add_u32 s35, s61, s59
    s_lshl_b32 s60, s3, 13
    s_mov_b32 m0, s60
    s_lshl_b32 s57, s3, 10
    s_lshr_b32 s62, s6, 4
    s_lshl2_add_u32 s62, s62, s7
    s_lshl_b32 s62, s62, 6
    s_and_b32 s63, s6, 15
    s_add_u32 s62, s62, s63
    s_lshl_b32 s62, s62, 6
    s_add_u32 s62, s62, 327680
    s_nop 0
    s_cmp_eq_u32 s3, 2
    s_cselect_b32 exec_lo, -1, 0
    s_mov_b32 exec_hi, 0
    s_waitcnt lgkmcnt(0)
    buffer_store_dwordx4 v[20:23], v3, s[8:11], s62 offen sc1
    s_cmp_lt_u32 s3, 2
    s_cselect_b64 exec, -1, 0
    buffer_load_dwordx4 v[16:19], v4, s[12:15], s57 offen
    s_mov_b64 exec, -1
    buffer_load_dwordx4 v7, s[16:19], s35 offen nt lds
    buffer_load_dwordx4 v11, s[16:19], s35 offen offset:1024 nt lds
    buffer_load_dwordx4 v12, s[16:19], s35 offen offset:2048 nt lds
    buffer_load_dwordx4 v13, s[16:19], s35 offen offset:3072 nt lds
    s_add_u32 m0, m0, 0x1000
    s_add_u32 s61, s35, 0x20000
    buffer_load_dwordx4 v7, s[16:19], s61 offen nt lds
    buffer_load_dwordx4 v11, s[16:19], s61 offen offset:1024 nt lds
    buffer_load_dwordx4 v12, s[16:19], s61 offen offset:2048 nt lds
    buffer_load_dwordx4 v13, s[16:19], s61 offen offset:3072 nt lds
    s_branch L_W2
L_A:
    s_and_b32 s6, s4, 1
    s_bfe_u32 s56, s4, 0x30001
    s_lshl3_add_u32 s7, s5, s56
    s_lshl_b32 s57, s7, 17
    s_lshl2_add_u32 s19, s6, s3
    s_lshl_b32 s19, s19, 14
    s_mov_b32 s50, 8388608
    s_mov_b32 s51, 0x20000
    s_mov_b32 m0, s19
    s_add_u32 s33, s19, s57
    s_mov_b32 s10, 5242880
    s_mov_b32 s11, 0x20000
    s_lshl_b32 s18, s6, 5
    s_add_u32 s18, s18, s3
    s_lshl_b32 s18, s18, 15
    s_lshl_b32 s56, s7, 9
    s_add_u32 s18, s18, s56
    s_add_u32 s18, s18, 1048576
    v_bfe_u32 v7, v1, 1, 3
    v_lshlrev_b32 v7, 17, v7
    v_and_b32 v2, 1, v1
    v_lshl_add_u32 v7, v2, 6, v7
    v_and_b32 v2, 48, v1
    v_add_u32 v7, v2, v7
    v_mov_b32 v8, -1
    v_mov_b32 v9, -1
    v_mov_b32 v10, -1
    v_mov_b32 v11, -1
    s_and_b32 s60, s4, 3
    s_lshl2_add_u32 s60, s60, s3
    s_lshl_b32 s60, s60, 18
    s_bfe_u32 s61, s4, 0x20002
    s_lshl2_add_u32 s61, s5, s61
    s_lshl_b32 s61, s61, 8
    s_add_u32 s60, s60, s61
    v_lshrrev_b32 v2, 1, v1
    v_and_b32 v3, 1, v1
    v_lshlrev_b32 v2, 13, v2
    v_lshl_add_u32 v2, v3, 7, v2
    v_add_u32 v6, s60, v2
    s_waitcnt lgkmcnt(0)
    global_load_dword v255, v6, s[20:21]
    buffer_store_dwordx4 v[8:11], v7, s[8:11], s18 offen offset:0 sc1
    buffer_store_dwordx4 v[8:11], v7, s[8:11], s18 offen offset:128 sc1
    buffer_store_dwordx4 v[8:11], v7, s[8:11], s18 offen offset:256 sc1
    buffer_store_dwordx4 v[8:11], v7, s[8:11], s18 offen offset:384 sc1
    s_nop 1
    v_xor_b32 v9, 16, v4
    v_xor_b32 v10, 32, v4
    v_xor_b32 v11, 48, v4
    buffer_load_dwordx4 v4, s[48:51], s33 offen offset:0 lds
    buffer_load_dwordx4 v9, s[48:51], s33 offen offset:1024 lds
    buffer_load_dwordx4 v10, s[48:51], s33 offen offset:2048 lds
    buffer_load_dwordx4 v11, s[48:51], s33 offen offset:3072 lds
    s_add_u32 m0, m0, 0x1000
    s_add_u32 s33, s33, 0x1000
    v_xor_b32 v8, 64, v4
    v_xor_b32 v9, 80, v4
    v_xor_b32 v10, 96, v4
    v_xor_b32 v11, 112, v4
    buffer_load_dwordx4 v8, s[48:51], s33 offen offset:0 lds
    buffer_load_dwordx4 v9, s[48:51], s33 offen offset:1024 lds
    buffer_load_dwordx4 v10, s[48:51], s33 offen offset:2048 lds
    buffer_load_dwordx4 v11, s[48:51], s33 offen offset:3072 lds
    s_add_u32 m0, m0, 0x1000
    s_add_u32 s33, s33, 0x1000
    s_getpc_b64 s[40:41]
    L_pc:
    v_lshlrev_b32 v2, 3, v4
    s_lshl2_add_u32 s56, s4, s3
    v_add_u32 v3, 0x2000, v2
    v_min_u32 v3, L_end-L_pc, v3
    s_cmp_eq_u32 s56, 64
    s_cselect_b64 exec, -1, 0
    global_load_dword v255, v2, s[40:41]
    global_load_dword v255, v3, s[40:41]
    s_mov_b64 exec, -1
    s_branch L_A2
L_W2:
    s_load_dword s43, s[8:9], 0
    s_load_dwordx2 s[24:25], s[0:1], 32
    s_load_dwordx2 s[28:29], s[0:1], 40
    s_mov_b32 s22, 4194304
    s_mov_b32 s23, 0x20000
    s_add_u32 s38, s62, s57
    v_and_b32 v2, 0x70, v4
    v_lshlrev_b32 v2, 3, v2
    s_lshl2_add_u32 s63, s6, s7
    s_lshl_b32 s63, s63, 10
    s_lshl_b32 s62, s3, 17
    s_add_u32 s63, s63, s62
    s_add_u32 s63, s63, 65536
    s_cmp_lt_u32 s3, 2
    s_cselect_b64 exec, 0xff, 0
    buffer_load_dword v254, v2, s[8:11], s63 offen
    s_mov_b64 exec, -1
    v_xor_b32 v2, v5, v6
    v_lshlrev_b32 v2, 4, v2
    v_lshl_add_u32 v26, v6, 13, v2
    v_xor_b32 v27, 0, v26
    v_add_u32 v27, 31744, v27
    v_xor_b32 v28, 64, v26
    v_add_u32 v28, 63488, v28
    v_xor_b32 v29, 64, v26
    v_add_u32 v29, 95232, v29
    v_xor_b32 v30, 128, v26
    v_xor_b32 v31, 128, v26
    v_add_u32 v31, 31744, v31
    v_xor_b32 v32, 192, v26
    v_add_u32 v32, 63488, v32
    v_xor_b32 v33, 192, v26
    v_add_u32 v33, 95232, v33
    s_add_u32 m0, s60, 32768
    s_add_u32 s61, s35, 0
    buffer_load_dwordx4 v26, s[20:23], s61 offen offset:0 lds
    buffer_load_dwordx4 v27, s[20:23], s61 offen offset:1024 lds
    buffer_load_dwordx4 v28, s[20:23], s61 offen offset:2048 lds
    buffer_load_dwordx4 v29, s[20:23], s61 offen offset:3072 lds
    v_bfe_u32 v38, v1, 2, 2
    v_and_b32 v39, 3, v1
    v_lshl_add_u32 v3, v38, 3, v39
    v_lshl_add_u32 v2, v3, 8, v2
    s_add_u32 s64, s60, 32768
    v_add_u32 v34, s64, v2
    v_xor_b32 v35, 64, v34
    v_xor_b32 v36, 128, v34
    v_xor_b32 v37, 192, v34
    v_lshlrev_b32 v24, 13, v1
    v_and_b32 v24, 0x8000, v24
    v_lshl_or_b32 v24, v6, 4, v24
    v_and_b32 v2, 1, v1
    v_mul_u32_u24 v40, 1056, v2
    v_lshl_add_u32 v40, v6, 4, v40
    s_lshl_b32 s63, s7, 8
    s_add_u32 s63, s63, 131072
    v_add_u32 v40, s63, v40
    v_lshlrev_b32 v42, 9, v2
    v_lshl_add_u32 v42, v6, 4, v42
    v_and_b32 v2, 2, v1
    v_lshl_add_u32 v42, v2, 5, v42
    v_and_b32 v2, 1, v6
    v_lshl_or_b32 v2, v2, 2, v38
    v_lshlrev_b32 v44, 5, v2
    s_lshl_b32 s63, s3, 6
    v_lshl_or_b32 v2, v39, 3, s63
    v_xor_b32 v2, v2, v44
    v_lshl_add_u32 v41, v6, 3, v38
    v_lshl_add_u32 v41, v41, 8, v2
    v_xor_b32 v45, 32, v41
    v_bfe_u32 v2, v1, 2, 1
    v_lshl_add_u32 v43, v39, 1, v2
    v_lshlrev_b32 v43, 9, v43
    v_lshl_add_u32 v43, v6, 5, v43
    v_and_b32 v2, 8, v1
    v_lshl_add_u32 v43, v2, 1, v43
    s_lshl_b32 s68, s6, 12
    s_add_u32 s68, s68, 65536
    s_lshl_b32 s63, s7, 10
    s_add_u32 s67, s68, s63
    s_lshl_b32 s63, s3, 7
    s_add_u32 s67, s67, s63
    s_mov_b32 s70, 0xcccccccc
    s_mov_b32 s71, s70
    s_lshl4_add_u32 s66, s5, s4
    s_lshl2_add_u32 s66, s66, s3
    s_lshl_b32 s66, s66, 2
    s_add_u32 s66, s66, 442368
    s_lshl2_add_u32 s69, s6, s7
    s_lshl_b32 s44, s69, 4
    s_add_u32 s44, s44, 425984
    s_cmp_lt_u32 s3, 2
    s_cbranch_scc1 L_W_ln
    s_waitcnt lgkmcnt(0)
    s_mul_i32 s42, s43, 0x9E3779B1
    s_add_u32 s42, s42, 0x7F4A7C15
    v_mov_b32 v48, s42
    v_mov_b32 v3, 0
    s_cmp_eq_u32 s3, 2
    s_cselect_b64 exec, 1, 0
    s_waitcnt vmcnt(4)
    buffer_store_dword v48, v3, s[8:11], s44 offen sc1
    s_mov_b64 exec, -1
    s_branch L_W_b0
L_W_ln:
    s_mul_i32 s63, s3, 1056
    s_add_u32 s63, s63, 131072
    v_add_u32 v3, s63, v4
    s_waitcnt vmcnt(13)
    v_lshlrev_b32 v52, 16, v16
    v_and_b32 v53, 0xffff0000, v16
    v_lshlrev_b32 v54, 16, v17
    v_and_b32 v55, 0xffff0000, v17
    v_lshlrev_b32 v56, 16, v18
    v_and_b32 v57, 0xffff0000, v18
    v_lshlrev_b32 v58, 16, v19
    v_and_b32 v59, 0xffff0000, v19
    v_pk_add_f32 v[72:73], v[52:53], v[54:55]
    v_pk_add_f32 v[74:75], v[56:57], v[58:59]
    v_pk_add_f32 v[72:73], v[72:73], v[74:75]
    v_add_f32 v68, v72, v73
    s_nop 1
    v_add_f32_dpp v68, v68, v68 row_ror:8 row_mask:0xf bank_mask:0xf
    s_nop 1
    v_add_f32_dpp v68, v68, v68 row_ror:4 row_mask:0xf bank_mask:0xf
    s_nop 1
    v_add_f32_dpp v68, v68, v68 row_ror:2 row_mask:0xf bank_mask:0xf
    s_nop 1
    v_add_f32_dpp v68, v68, v68 row_ror:1 row_mask:0xf bank_mask:0xf
    s_nop 1
    v_mov_b32 v70, v68
    s_nop 1
    v_permlane16_swap_b32 v70, v68
    s_nop 0
    v_add_f32 v68, v68, v70
    v_mov_b32 v70, v68
    s_nop 1
    v_permlane32_swap_b32 v70, v68
    s_nop 0
    v_add_f32 v68, v68, v70
    v_mul_f32 v68, 0x3b000000, v68
    v_pk_add_f32 v[60:61], v[52:53], v[68:69] op_sel_hi:[1,0] neg_lo:[0,1] neg_hi:[0,1]
    v_pk_add_f32 v[62:63], v[54:55], v[68:69] op_sel_hi:[1,0] neg_lo:[0,1] neg_hi:[0,1]
    v_pk_add_f32 v[64:65], v[56:57], v[68:69] op_sel_hi:[1,0] neg_lo:[0,1] neg_hi:[0,1]
    v_pk_add_f32 v[66:67], v[58:59], v[68:69] op_sel_hi:[1,0] neg_lo:[0,1] neg_hi:[0,1]
    v_pk_mul_f32 v[72:73], v[60:61], v[60:61]
    v_pk_mul_f32 v[74:75], v[62:63], v[62:63]
    v_pk_fma_f32 v[72:73], v[64:65], v[64:65], v[72:73]
    v_pk_fma_f32 v[74:75], v[66:67], v[66:67], v[74:75]
    v_pk_add_f32 v[72:73], v[72:73], v[74:75]
    v_add_f32 v76, v72, v73
    v_cvt_pk_bf16_f32 v68, v68, v68
    v_and_b32 v68, 0xffff0000, v68
    v_add_f32_dpp v76, v76, v76 row_ror:8 row_mask:0xf bank_mask:0xf
    s_nop 1
    v_add_f32_dpp v76, v76, v76 row_ror:4 row_mask:0xf bank_mask:0xf
    s_nop 1
    v_add_f32_dpp v76, v76, v76 row_ror:2 row_mask:0xf bank_mask:0xf
    s_nop 1
    v_add_f32_dpp v76, v76, v76 row_ror:1 row_mask:0xf bank_mask:0xf
    s_nop 1
    v_mov_b32 v70, v76
    s_nop 1
    v_permlane16_swap_b32 v70, v76
    s_nop 0
    v_add_f32 v76, v76, v70
    v_mov_b32 v70, v76
    s_nop 1
    v_permlane32_swap_b32 v70, v76
    s_nop 0
    v_add_f32 v76, v76, v70
    v_mul_f32 v76, 0x3b000000, v76
    v_pk_add_f32 v[52:53], v[52:53], v[68:69] op_sel_hi:[1,0] neg_lo:[0,1] neg_hi:[0,1]
    v_pk_add_f32 v[54:55], v[54:55], v[68:69] op_sel_hi:[1,0] neg_lo:[0,1] neg_hi:[0,1]
    v_cvt_pk_bf16_f32 v76, v76, v76
    v_pk_add_f32 v[56:57], v[56:57], v[68:69] op_sel_hi:[1,0] neg_lo:[0,1] neg_hi:[0,1]
    v_pk_add_f32 v[58:59], v[58:59], v[68:69] op_sel_hi:[1,0] neg_lo:[0,1] neg_hi:[0,1]
    v_and_b32 v76, 0xffff0000, v76
    v_add_f32 v76, 0x3727c5ac, v76
    v_cvt_pk_bf16_f32 v16, v52, v53
    v_cvt_pk_bf16_f32 v76, v76, v76
    v_cvt_pk_bf16_f32 v17, v54, v55
    v_and_b32 v76, 0xffff0000, v76
    v_sqrt_f32 v76, v76
    v_cvt_pk_bf16_f32 v18, v56, v57
    v_cvt_pk_bf16_f32 v19, v58, v59
    v_cvt_pk_bf16_f32 v76, v76, v76
    v_lshlrev_b32 v52, 16, v16
    v_and_b32 v53, 0xffff0000, v16
    v_lshlrev_b32 v54, 16, v17
    v_and_b32 v55, 0xffff0000, v17
    v_and_b32 v68, 0xffff0000, v76
    v_rcp_f32 v68, v68
    v_lshlrev_b32 v56, 16, v18
    v_and_b32 v57, 0xffff0000, v18
    v_lshlrev_b32 v58, 16, v19
    v_and_b32 v59, 0xffff0000, v19
    v_pk_mul_f32 v[52:53], v[52:53], v[68:69] op_sel_hi:[1,0]
    v_pk_mul_f32 v[54:55], v[54:55], v[68:69] op_sel_hi:[1,0]
    v_pk_mul_f32 v[56:57], v[56:57], v[68:69] op_sel_hi:[1,0]
    v_pk_mul_f32 v[58:59], v[58:59], v[68:69] op_sel_hi:[1,0]
    v_cvt_pk_bf16_f32 v16, v52, v53
    v_cvt_pk_bf16_f32 v17, v54, v55
    v_cvt_pk_bf16_f32 v18, v56, v57
    v_cvt_pk_bf16_f32 v19, v58, v59
    ds_write_b128 v3, v[16:19]
    s_waitcnt lgkmcnt(0)
    s_mul_i32 s42, s43, 0x9E3779B1
    s_add_u32 s42, s42, 0x7F4A7C15
    v_mov_b32 v48, s42
    s_waitcnt vmcnt(5)
L_W_b0:
    s_mov_b32 s1, s69
    s_barrier
    ds_read_b128 v[80:83], v40 offset:0
    ds_read_b64_tr_b16 v[152:153], v41 offset:0
    ds_read_b64_tr_b16 v[154:155], v41 offset:1024
    ds_read_b64_tr_b16 v[156:157], v45 offset:0
    ds_read_b64_tr_b16 v[158:159], v45 offset:1024
    ds_read_b128 v[84:87], v40 offset:64
    ds_read_b64_tr_b16 v[160:161], v41 offset:8192
    ds_read_b64_tr_b16 v[162:163], v41 offset:9216
    ds_read_b64_tr_b16 v[164:165], v45 offset:8192
    ds_read_b64_tr_b16 v[166:167], v45 offset:9216
    ds_read_b128 v[88:91], v40 offset:128
    ds_read_b64_tr_b16 v[168:169], v41 offset:16384
    ds_read_b64_tr_b16 v[170:171], v41 offset:17408
    ds_read_b64_tr_b16 v[172:173], v45 offset:16384
    ds_read_b64_tr_b16 v[174:175], v45 offset:17408
    s_waitcnt lgkmcnt(14)
    ds_read_b128 v[92:95], v40 offset:192
    s_waitcnt lgkmcnt(13)
    ds_read_b64_tr_b16 v[176:177], v41 offset:24576
    ds_read_b64_tr_b16 v[178:179], v41 offset:25600
    s_waitcnt lgkmcnt(13)
    ds_read_b64_tr_b16 v[180:181], v45 offset:24576
    ds_read_b64_tr_b16 v[182:183], v45 offset:25600
    v_mfma_f32_16x16x32_bf16 v[144:147], v[152:155], v[80:83], 0
    v_mfma_f32_16x16x32_bf16 v[148:151], v[156:159], v[80:83], 0
    s_waitcnt lgkmcnt(12)
    v_mfma_f32_16x16x32_bf16 v[144:147], v[160:163], v[84:87], v[144:147]
    s_waitcnt lgkmcnt(10)
    v_mfma_f32_16x16x32_bf16 v[148:151], v[164:167], v[84:87], v[148:151]
    s_waitcnt lgkmcnt(7)
    v_mfma_f32_16x16x32_bf16 v[144:147], v[168:171], v[88:91], v[144:147]
    s_waitcnt lgkmcnt(5)
    v_mfma_f32_16x16x32_bf16 v[148:151], v[172:175], v[88:91], v[148:151]
    s_waitcnt lgkmcnt(2)
    v_mfma_f32_16x16x32_bf16 v[144:147], v[176:179], v[92:95], v[144:147]
    s_waitcnt lgkmcnt(0)
    v_mfma_f32_16x16x32_bf16 v[148:151], v[180:183], v[92:95], v[148:151]
    s_mov_b32 exec_lo, 0x000f000f
    s_mov_b32 exec_hi, 0x000f000f
    s_nop 4
    v_cvt_pk_bf16_f32 v50, v144, v145
    v_cvt_pk_bf16_f32 v51, v146, v147
    v_cvt_pk_bf16_f32 v2, v148, v149
    v_cvt_pk_bf16_f32 v3, v150, v151
    v_cndmask_b32 v50, v50, v2, s[70:71]
    v_cndmask_b32 v51, v51, v3, s[70:71]
    buffer_store_dwordx4 v[48:51], v42, s[8:11], s67 offen
    s_mov_b64 exec, -1
    s_and_b32 s62, s6, 15
    s_cmp_lg_u32 s62, 0
    s_cbranch_scc1 L_W_nx
    s_lshr_b32 s62, s6, 4
    s_lshl2_add_u32 s62, s62, s7
    s_lshl_b32 s62, s62, 9
    s_add_u32 s62, s62, 450560
    v_lshlrev_b32 v2, 6, v5
    v_lshl_add_u32 v2, v6, 4, v2
    s_cmp_eq_u32 s3, 0
    s_cselect_b32 exec_lo, 0x00030003, 0
    s_mov_b32 exec_hi, exec_lo
    buffer_store_dwordx4 v[80:83], v2, s[8:11], s62 offen offset:0 sc1
    buffer_store_dwordx4 v[84:87], v2, s[8:11], s62 offen offset:128 sc1
    buffer_store_dwordx4 v[88:91], v2, s[8:11], s62 offen offset:256 sc1
    buffer_store_dwordx4 v[92:95], v2, s[8:11], s62 offen offset:384 sc1
    s_mov_b64 exec, -1
L_W_nx:
    s_mov_b32 s63, 0
    s_add_u32 m0, s60, 36864
    s_add_u32 s61, s35, 131072
    buffer_load_dwordx4 v30, s[20:23], s61 offen offset:0 lds
    buffer_load_dwordx4 v31, s[20:23], s61 offen offset:1024 lds
    buffer_load_dwordx4 v32, s[20:23], s61 offen offset:2048 lds
    buffer_load_dwordx4 v33, s[20:23], s61 offen offset:3072 lds
    s_waitcnt vmcnt(0)
    buffer_load_dwordx4 v[152:155], v43, s[8:11], s68 offen offset:0 sc1
    buffer_load_dwordx4 v[160:163], v43, s[8:11], s68 offen offset:128 sc1
    buffer_load_dwordx4 v[168:171], v43, s[8:11], s68 offen offset:256 sc1
    buffer_load_dwordx4 v[176:179], v43, s[8:11], s68 offen offset:384 sc1
    ds_read_b128 v[96:99], v34 offset:0
    ds_read_b128 v[112:115], v34 offset:1024
    ds_read_b128 v[100:103], v35 offset:0
    ds_read_b128 v[116:119], v35 offset:1024
    ds_read_b128 v[104:107], v36 offset:0
    ds_read_b128 v[120:123], v36 offset:1024
    ds_read_b128 v[108:111], v37 offset:0
    ds_read_b128 v[124:127], v37 offset:1024
    s_branch L_Wa_c
L_Wa:
    s_cmp_lg_u32 s63, 4
    s_cbranch_scc1 L_Wa_n
    s_mov_b32 exec_lo, 0x000f000f
    s_mov_b32 exec_hi, 0x000f000f
    buffer_store_dwordx4 v[48:51], v42, s[8:11], s67 offen sc1
    s_mov_b64 exec, -1
L_Wa_n:
    buffer_load_dwordx4 v[152:155], v43, s[8:11], s68 offen offset:0 sc1
    buffer_load_dwordx4 v[160:163], v43, s[8:11], s68 offen offset:128 sc1
    buffer_load_dwordx4 v[168:171], v43, s[8:11], s68 offen offset:256 sc1
    buffer_load_dwordx4 v[176:179], v43, s[8:11], s68 offen offset:384 sc1
L_Wa_c:
    s_add_u32 s63, s63, 1
    s_cmp_gt_u32 s63, 20000
    s_cbranch_scc1 L_Wa_x
    s_waitcnt vmcnt(0)
    v_sad_u32 v184, v152, s42, 0
    v_sad_u32 v184, v160, s42, v184
    v_sad_u32 v184, v168, s42, v184
    v_sad_u32 v184, v176, s42, v184
    v_cmp_ne_u32 vcc, 0, v184
    s_cbranch_vccnz L_Wa
L_Wa_x:
    s_waitcnt vmcnt(0)
    v_mov_b32_dpp v156, v154 row_ror:8 row_mask:0xf bank_mask:0xf
    v_mov_b32_dpp v157, v155 row_ror:8 row_mask:0xf bank_mask:0xf
    v_mov_b32_dpp v164, v162 row_ror:8 row_mask:0xf bank_mask:0xf
    v_mov_b32_dpp v165, v163 row_ror:8 row_mask:0xf bank_mask:0xf
    v_mov_b32_dpp v172, v170 row_ror:8 row_mask:0xf bank_mask:0xf
    v_mov_b32_dpp v173, v171 row_ror:8 row_mask:0xf bank_mask:0xf
    v_mov_b32_dpp v180, v178 row_ror:8 row_mask:0xf bank_mask:0xf
    v_mov_b32_dpp v181, v179 row_ror:8 row_mask:0xf bank_mask:0xf
    s_waitcnt lgkmcnt(0)
    v_mfma_f32_16x16x32_bf16 v[144:147], v[96:99], v[154:157], 0
    v_mfma_f32_16x16x32_bf16 v[148:151], v[112:115], v[154:157], 0
    v_mfma_f32_16x16x32_bf16 v[144:147], v[100:103], v[162:165], v[144:147]
    v_mfma_f32_16x16x32_bf16 v[148:151], v[116:119], v[162:165], v[148:151]
    v_mfma_f32_16x16x32_bf16 v[144:147], v[104:107], v[170:173], v[144:147]
    v_mfma_f32_16x16x32_bf16 v[148:151], v[120:123], v[170:173], v[148:151]
    v_mfma_f32_16x16x32_bf16 v[144:147], v[108:111], v[178:181], v[144:147]
    v_mfma_f32_16x16x32_bf16 v[148:151], v[124:127], v[178:181], v[148:151]
    s_nop 6
    v_add_f32_dpp v144, v144, v144 quad_perm:[1,0,3,2] row_mask:0xf bank_mask:0xf
    v_add_f32_dpp v145, v145, v145 quad_perm:[1,0,3,2] row_mask:0xf bank_mask:0xf
    v_add_f32_dpp v146, v146, v146 quad_perm:[1,0,3,2] row_mask:0xf bank_mask:0xf
    v_add_f32_dpp v147, v147, v147 quad_perm:[1,0,3,2] row_mask:0xf bank_mask:0xf
    v_add_f32_dpp v148, v148, v148 quad_perm:[1,0,3,2] row_mask:0xf bank_mask:0xf
    v_add_f32_dpp v149, v149, v149 quad_perm:[1,0,3,2] row_mask:0xf bank_mask:0xf
    v_add_f32_dpp v150, v150, v150 quad_perm:[1,0,3,2] row_mask:0xf bank_mask:0xf
    v_add_f32_dpp v151, v151, v151 quad_perm:[1,0,3,2] row_mask:0xf bank_mask:0xf
    v_add_f32_dpp v144, v144, v144 quad_perm:[2,3,0,1] row_mask:0xf bank_mask:0xf
    v_add_f32_dpp v145, v145, v145 quad_perm:[2,3,0,1] row_mask:0xf bank_mask:0xf
    v_add_f32_dpp v146, v146, v146 quad_perm:[2,3,0,1] row_mask:0xf bank_mask:0xf
    v_add_f32_dpp v147, v147, v147 quad_perm:[2,3,0,1] row_mask:0xf bank_mask:0xf
    v_add_f32_dpp v148, v148, v148 quad_perm:[2,3,0,1] row_mask:0xf bank_mask:0xf
    v_add_f32_dpp v149, v149, v149 quad_perm:[2,3,0,1] row_mask:0xf bank_mask:0xf
    v_add_f32_dpp v150, v150, v150 quad_perm:[2,3,0,1] row_mask:0xf bank_mask:0xf
    v_add_f32_dpp v151, v151, v151 quad_perm:[2,3,0,1] row_mask:0xf bank_mask:0xf
    v_cvt_pk_bf16_f32 v188, v144, v145
    v_cvt_pk_bf16_f32 v189, v146, v147
    v_cvt_pk_bf16_f32 v190, v148, v149
    v_cvt_pk_bf16_f32 v191, v150, v151
    s_mov_b32 exec_lo, 0x00110011
    s_mov_b32 exec_hi, 0x00110011
    buffer_store_dwordx4 v[188:191], v24, s[8:11], s38 offen sc1
    s_mov_b64 exec, 1
    buffer_store_dword v48, v4, s[8:11], s66 offen
    s_mov_b64 exec, -1
    s_lshl_b32 s58, s3, 8
    v_and_b32 v2, 0xff, v7
    v_lshl_add_u32 v26, v6, 10, v2
    v_xor_b32 v27, 0x80, v26
    v_add_u32 v28, 3072, v26
    v_add_u32 v31, 6144, v27
    v_add_u32 v32, 9216, v27
    v_mov_b32 v196, 0
    s_mov_b32 exec_lo, 0x000f000f
    s_mov_b32 exec_hi, 0x000f000f
    buffer_store_dwordx4 v[48:51], v42, s[8:11], s67 offen sc1
    s_mov_b64 exec, -1
    s_mov_b32 s26, 4194304
    s_mov_b32 s27, 0x20000
    s_waitcnt vmcnt(0)
    s_add_u32 m0, s60, 0
    s_add_u32 s61, s35, 0
    buffer_load_dwordx4 v7, s[24:27], s61 offen nt lds
    buffer_load_dwordx4 v11, s[24:27], s61 offen offset:1024 nt lds
    buffer_load_dwordx4 v12, s[24:27], s61 offen offset:2048 nt lds
    buffer_load_dwordx4 v13, s[24:27], s61 offen offset:3072 nt lds
    s_lshr_b32 s17, s6, 1
    s_lshl2_add_u32 s17, s17, s7
    s_lshl_b32 s17, s17, 15
    s_add_u32 s17, s17, s60
    s_and_b32 s63, s6, 1
    s_lshl_b32 s63, s63, 6
    s_add_u32 s17, s17, s63
    s_add_u32 s17, s17, 1048576
    s_add_u32 s47, s17, 0x1000
    v_lshlrev_b32 v197, 9, v6
    v_lshl_add_u32 v197, v38, 7, v197
    v_lshl_add_u32 v197, v39, 4, v197
    v_lshrrev_b32 v25, 1, v1
    v_mul_u32_u24 v25, 7168, v25
    v_and_b32 v2, 1, v1
    v_lshl_or_b32 v25, v2, 4, v25
    s_lshl4_add_u32 s62, s5, s4
    s_lshl_b32 s62, s62, 5
    s_mul_i32 s63, s3, 229376
    s_add_u32 s62, s62, s63
    s_add_u32 s39, s62, 4194304
    s_mov_b32 s30, 4194304
    s_mov_b32 s31, 0x20000
    v_lshl_or_b32 v44, v39, 3, v44
    v_lshlrev_b32 v216, 6, v38
    v_lshl_add_u32 v216, v6, 5, v216
    v_lshl_add_u32 v216, v39, 3, v216
    s_mul_i32 s62, s3, 288
    s_add_u32 s62, s62, 133376
    v_add_u32 v216, s62, v216
    v_mul_u32_u24 v217, 288, v39
    v_lshl_add_u32 v217, v6, 4, v217
    v_add_u32 v217, 133376, v217
    v_bfe_u32 v218, v1, 1, 1
    v_lshlrev_b32 v218, 9, v218
    v_lshl_add_u32 v218, v6, 4, v218
    v_and_b32 v2, 1, v1
    v_lshl_add_u32 v218, v2, 6, v218
    v_and_b32 v2, 7, v1
    v_lshlrev_b32 v2, 9, v2
    v_lshl_add_u32 v2, v6, 5, v2
    v_and_b32 v3, 8, v1
    v_lshl_add_u32 v219, v3, 1, v2
    s_lshl_b32 s62, s3, 6
    v_lshlrev_b32 v220, 2, v6
    v_add_u32 v220, s62, v220
    v_and_b32 v2, 1, v1
    v_lshlrev_b32 v2, 4, v2
    v_mov_b32 v3, 0xffff
    v_lshlrev_b32 v3, v2, v3
    v_bfe_u32 v2, v1, 1, 2
    v_cmp_eq_u32 vcc, 0, v2
    s_nop 1
    v_cndmask_b32 v60, 0, v3, vcc
    v_cmp_eq_u32 vcc, 1, v2
    s_nop 1
    v_cndmask_b32 v61, 0, v3, vcc
    v_cmp_eq_u32 vcc, 2, v2
    s_nop 1
    v_cndmask_b32 v62, 0, v3, vcc
    v_cmp_eq_u32 vcc, 3, v2
    s_nop 1
    v_cndmask_b32 v63, 0, v3, vcc
    s_lshl_b32 s46, s1, 15
    s_add_u32 s46, s46, s58
    v_lshl_add_u32 v3, v6, 3, v38
    v_lshlrev_b32 v3, 8, v3
    s_add_u32 s62, s60, 65536
    v_add_u32 v3, s62, v3
    v_xor_b32 v52, 0, v44
    v_add_u32 v52, v52, v3
    v_xor_b32 v53, 32, v44
    v_add_u32 v53, v53, v3
    v_xor_b32 v54, 64, v44
    v_add_u32 v54, v54, v3
    v_xor_b32 v55, 96, v44
    v_add_u32 v55, v55, v3
    v_xor_b32 v56, 128, v44
    v_add_u32 v56, v56, v3
    v_xor_b32 v57, 160, v44
    v_add_u32 v57, v57, v3
    v_xor_b32 v58, 192, v44
    v_add_u32 v58, v58, v3
    v_xor_b32 v59, 224, v44
    v_add_u32 v59, v59, v3
    v_mov_b32 v194, v48
    v_mov_b32 v224, 0
    v_mov_b32 v225, 0
    v_mov_b32 v226, 0
    v_mov_b32 v227, 0
    v_mov_b32 v228, 0
    v_mov_b32 v229, 0
    v_mov_b32 v230, 0
    v_mov_b32 v231, 0
    s_lshl_b32 s62, s5, 8
    s_add_u32 s62, s62, 442368
    v_lshlrev_b32 v3, 2, v1
    s_mov_b32 s63, 0
L_Wg:
    buffer_load_dword v2, v3, s[8:11], s62 offen offset:0 sc1
    s_add_u32 s63, s63, 1
    s_cmp_gt_u32 s63, HINT_LIMIT
    s_cbranch_scc1 L_Wg_x
    s_waitcnt vmcnt(0)
    v_cmp_ne_u32 vcc, s42, v2
    s_cbranch_vccnz L_Wg
L_Wg_x:
    s_add_u32 m0, s60, 4096
    s_add_u32 s61, s35, 131072
    buffer_load_dwordx4 v7, s[24:27], s61 offen nt lds
    buffer_load_dwordx4 v11, s[24:27], s61 offen offset:1024 nt lds
    buffer_load_dwordx4 v12, s[24:27], s61 offen offset:2048 nt lds
    buffer_load_dwordx4 v13, s[24:27], s61 offen offset:3072 nt lds
    s_add_u32 m0, s60, 65536
    s_nop 0
    buffer_load_dwordx4 v26, s[28:31], s46 offen offset:0 lds
    buffer_load_dwordx4 v28, s[28:31], s46 offen offset:1024 lds
    buffer_load_dwordx4 v31, s[28:31], s46 offen offset:2048 lds
    buffer_load_dwordx4 v32, s[28:31], s46 offen offset:3072 lds
    buffer_load_dword v254, v25, s[8:11], s39 offen
    s_lshr_b32 s16, s6, 2
    s_lshl_b32 s16, s16, 8
    s_and_b32 s63, s6, 3
    s_add_u32 s16, s16, s63
    s_lshl_b32 s16, s16, 4
    s_add_u32 s16, s16, 3670016
    v_lshlrev_b32 v237, 6, v1
    s_lshl_b32 s62, s6, 12
    s_add_u32 s62, s62, 196608
    s_lshl_b32 s63, s7, 7
    s_add_u32 s19, s62, s63
    s_lshl_b32 s63, s7, 10
    s_add_u32 s18, s62, s63
    s_lshl_b32 s63, s3, 7
    s_add_u32 s18, s18, s63
    s_lshr_b32 s21, s3, 1
    s_lshl_b32 s21, s21, 5
    s_mov_b32 s70, 0xaaaaaaaa
    s_mov_b32 s71, s70
    s_waitcnt vmcnt(5)
    s_barrier
    s_add_u32 m0, m0, 0x1000
    s_add_u32 s46, s46, 0x4000
    buffer_load_dwordx4 v26, s[28:31], s46 offen offset:0 lds
    buffer_load_dwordx4 v28, s[28:31], s46 offen offset:1024 lds
    buffer_load_dwordx4 v31, s[28:31], s46 offen offset:2048 lds
    buffer_load_dwordx4 v32, s[28:31], s46 offen offset:3072 lds
    ds_read_b64_tr_b16 v[96:97], v41 offset:0
    ds_read_b64_tr_b16 v[98:99], v41 offset:1024
    ds_read_b64_tr_b16 v[112:113], v45 offset:0
    ds_read_b64_tr_b16 v[114:115], v45 offset:1024
    ds_read_b64_tr_b16 v[100:101], v41 offset:8192
    ds_read_b64_tr_b16 v[102:103], v41 offset:9216
    ds_read_b64_tr_b16 v[116:117], v45 offset:8192
    ds_read_b64_tr_b16 v[118:119], v45 offset:9216
    ds_read_b64_tr_b16 v[104:105], v41 offset:16384
    ds_read_b64_tr_b16 v[106:107], v41 offset:17408
    ds_read_b64_tr_b16 v[120:121], v45 offset:16384
    ds_read_b64_tr_b16 v[122:123], v45 offset:17408
    ds_read_b64_tr_b16 v[108:109], v41 offset:24576
    ds_read_b64_tr_b16 v[110:111], v41 offset:25600
    ds_read_b64_tr_b16 v[124:125], v45 offset:24576
    s_waitcnt lgkmcnt(14)
    ds_read_b64_tr_b16 v[126:127], v45 offset:25600
    s_waitcnt vmcnt(0)
    s_waitcnt lgkmcnt(14)
    ds_read_b64_tr_b16 a[0:1], v52 offset:0
    s_waitcnt lgkmcnt(14)
    ds_read_b64_tr_b16 a[2:3], v52 offset:1024
    s_waitcnt lgkmcnt(14)
    ds_read_b64_tr_b16 a[4:5], v53 offset:0
    s_waitcnt lgkmcnt(14)
    ds_read_b64_tr_b16 a[6:7], v53 offset:1024
    s_waitcnt lgkmcnt(14)
    ds_read_b64_tr_b16 a[8:9], v54 offset:0
    s_waitcnt lgkmcnt(14)
    ds_read_b64_tr_b16 a[10:11], v54 offset:1024
    s_waitcnt lgkmcnt(14)
    ds_read_b64_tr_b16 a[12:13], v55 offset:0
    s_waitcnt lgkmcnt(14)
    ds_read_b64_tr_b16 a[14:15], v55 offset:1024
    s_waitcnt lgkmcnt(14)
    ds_read_b64_tr_b16 a[16:17], v56 offset:0
    s_waitcnt lgkmcnt(14)
    ds_read_b64_tr_b16 a[18:19], v56 offset:1024
    s_waitcnt lgkmcnt(14)
    ds_read_b64_tr_b16 a[20:21], v57 offset:0
    s_waitcnt lgkmcnt(14)
    ds_read_b64_tr_b16 a[22:23], v57 offset:1024
    s_waitcnt lgkmcnt(14)
    ds_read_b64_tr_b16 a[24:25], v58 offset:0
    s_waitcnt lgkmcnt(14)
    ds_read_b64_tr_b16 a[26:27], v58 offset:1024
    s_waitcnt lgkmcnt(14)
    ds_read_b64_tr_b16 a[28:29], v59 offset:0
    s_waitcnt lgkmcnt(14)
    ds_read_b64_tr_b16 a[30:31], v59 offset:1024
    s_and_b32 s62, s4, 14
    s_lshr_b32 s63, s5, 2
    s_or_b32 s62, s62, s63
    s_lshl4_add_u32 s62, s5, s62
    s_lshl_b32 s62, s62, 7
    s_add_u32 s45, s62, 393216
    s_lshl2_add_u32 s62, s7, s45
    s_mov_b32 s20, 0
L_Wh1:
    buffer_load_dword v2, v196, s[8:11], s45 offen offset:0 sc1
    s_add_u32 s20, s20, 1
    s_cmp_gt_u32 s20, HINT_LIMIT
    s_cbranch_scc1 L_Wh1_x
    s_waitcnt vmcnt(0)
    v_cmp_ne_u32 vcc, s42, v2
    s_cbranch_vccnz L_Wh1
L_Wh1_x:
    s_mov_b32 s20, 0
L_Ws:
    s_sleep 1
    buffer_load_dwordx3 v[16:18], v237, s[8:11], s16 offen sc1
    buffer_load_dword v19, v196, s[8:11], s62 offen offset:16 sc1
    s_add_u32 s20, s20, 1
    s_cmp_gt_u32 s20, 20000
    s_cbranch_scc1 L_Ws_x
    s_waitcnt vmcnt(0)
    v_cmp_ne_u32 vcc, s42, v18
    s_cbranch_vccnz L_Ws
L_Ws_x:
    s_waitcnt vmcnt(0)
    v_cmp_ne_u32 s[64:65], s42, v19
    s_cmp_lg_u64 s[64:65], 0
    s_cbranch_scc1 L_Wp_n1
    buffer_load_dwordx4 v[152:155], v197, s[8:11], s17 offen offset:0 sc1
    buffer_load_dwordx4 v[156:159], v197, s[8:11], s17 offen offset:2048 sc1
    buffer_load_dwordx4 v[160:163], v197, s[8:11], s47 offen offset:0 sc1
    buffer_load_dwordx4 v[164:167], v197, s[8:11], s47 offen offset:2048 sc1
L_Wp_n1:
    v_mov_b32 v21, v16
    s_nop 1
    v_max_f32_dpp v21, v21, v21 row_ror:8 row_mask:0xf bank_mask:0xf
    s_nop 1
    v_max_f32_dpp v21, v21, v21 row_ror:4 row_mask:0xf bank_mask:0xf
    s_nop 1
    v_max_f32_dpp v21, v21, v21 row_ror:2 row_mask:0xf bank_mask:0xf
    s_nop 1
    v_max_f32_dpp v21, v21, v21 row_ror:1 row_mask:0xf bank_mask:0xf
    s_nop 1
    v_mov_b32 v70, v21
    s_nop 1
    v_permlane16_swap_b32 v70, v21
    s_nop 0
    v_max_f32 v21, v21, v70
    v_sub_f32 v21, v16, v21
    v_exp_f32 v21, v21
    s_nop 0
    v_cvt_pk_bf16_f32 v20, v21, v21
    s_waitcnt lgkmcnt(14)
    ds_bpermute_b32 v64, v220, v20 offset:0
    s_waitcnt lgkmcnt(14)
    ds_bpermute_b32 v65, v220, v20 offset:16
    s_waitcnt lgkmcnt(14)
    ds_bpermute_b32 v66, v220, v20 offset:32
    s_waitcnt lgkmcnt(14)
    ds_bpermute_b32 v67, v220, v20 offset:48
    v_and_b32 v21, 0xffff0000, v20
    v_mul_f32 v21, v21, v17
    s_nop 1
    v_add_f32_dpp v21, v21, v21 row_ror:8 row_mask:0xf bank_mask:0xf
    s_nop 1
    v_add_f32_dpp v21, v21, v21 row_ror:4 row_mask:0xf bank_mask:0xf
    s_nop 1
    v_add_f32_dpp v21, v21, v21 row_ror:2 row_mask:0xf bank_mask:0xf
    s_nop 1
    v_add_f32_dpp v21, v21, v21 row_ror:1 row_mask:0xf bank_mask:0xf
    s_nop 1
    v_mov_b32 v70, v21
    s_nop 1
    v_permlane16_swap_b32 v70, v21
    s_nop 0
    v_add_f32 v21, v21, v70
    v_rcp_f32 v21, v21
    s_waitcnt lgkmcnt(0)
    v_and_b32 v128, v64, v60
    v_and_b32 v129, v64, v61
    v_and_b32 v130, v64, v62
    v_and_b32 v131, v64, v63
    v_and_b32 v132, v65, v60
    v_and_b32 v133, v65, v61
    v_and_b32 v134, v65, v62
    v_and_b32 v135, v65, v63
    v_and_b32 v136, v66, v60
    v_and_b32 v137, v66, v61
    v_and_b32 v138, v66, v62
    v_and_b32 v139, v66, v63
    v_and_b32 v140, v67, v60
    v_and_b32 v141, v67, v61
    v_and_b32 v142, v67, v62
    v_and_b32 v143, v67, v63
    v_readlane_b32 s22, v21, s21
    s_cmp_eq_u64 s[64:65], 0
    s_cbranch_scc1 L_Wp_n2
    s_mov_b32 s20, 0
L_Wh2:
    buffer_load_dword v2, v196, s[8:11], s62 offen offset:16 sc1
    s_add_u32 s20, s20, 1
    s_cmp_gt_u32 s20, HINT_LIMIT
    s_cbranch_scc1 L_Wh2_x
    s_waitcnt vmcnt(0)
    v_cmp_ne_u32 vcc, s42, v2
    s_cbranch_vccnz L_Wh2
L_Wh2_x:
    buffer_load_dwordx4 v[152:155], v197, s[8:11], s17 offen offset:0 sc1
    buffer_load_dwordx4 v[156:159], v197, s[8:11], s17 offen offset:2048 sc1
    buffer_load_dwordx4 v[160:163], v197, s[8:11], s47 offen offset:0 sc1
    buffer_load_dwordx4 v[164:167], v197, s[8:11], s47 offen offset:2048 sc1
L_Wp_n2:
    s_lshl4_add_u32 s62, s5, s4
    s_lshl2_add_u32 s62, s62, s3
    s_lshl_b32 s62, s62, 3
    s_add_u32 s62, s62, 409600
    s_mov_b32 s61, s20
    s_mov_b32 s20, 0
    s_branch L_Wp_c
L_Wp:
    buffer_load_dwordx4 v[152:155], v197, s[8:11], s17 offen offset:0 sc1
    buffer_load_dwordx4 v[156:159], v197, s[8:11], s17 offen offset:2048 sc1
    buffer_load_dwordx4 v[160:163], v197, s[8:11], s47 offen offset:0 sc1
    buffer_load_dwordx4 v[164:167], v197, s[8:11], s47 offen offset:2048 sc1
L_Wp_c:
    s_add_u32 s20, s20, 1
    s_cmp_gt_u32 s20, 20000
    s_cbranch_scc1 L_Wp_x
    s_waitcnt vmcnt(0)
L_Wp_d:
    v_max3_u32 v184, v155, v159, v163
    v_max_u32 v184, v184, v167
    v_cmp_eq_u32 vcc, -1, v184
    s_cbranch_vccnz L_Wp
L_Wp_x:
    v_mfma_f32_16x16x32_bf16 v[144:147], v[128:131], v[152:155], 0
    v_mfma_f32_16x16x32_bf16 v[144:147], v[132:135], v[156:159], v[144:147]
    v_mfma_f32_16x16x32_bf16 v[144:147], v[136:139], v[160:163], v[144:147]
    v_mfma_f32_16x16x32_bf16 v[144:147], v[140:143], v[164:167], v[144:147]
    s_mov_b32 exec_hi, 0
    s_nop 6
    v_mul_f32 v144, s22, v144
    v_mul_f32 v145, s22, v145
    v_mul_f32 v146, s22, v146
    v_mul_f32 v147, s22, v147
    v_cvt_pk_bf16_f32 v188, v144, v145
    v_cvt_pk_bf16_f32 v189, v146, v147
    ds_write_b64 v216, v[188:189]
    s_mov_b64 exec, -1
    s_waitcnt lgkmcnt(0)
    s_barrier
    ds_read_b128 v[80:83], v217 offset:0
    ds_read_b128 v[84:87], v217 offset:64
    ds_read_b128 v[88:91], v217 offset:128
    ds_read_b128 v[92:95], v217 offset:192
    s_waitcnt lgkmcnt(3)
    v_mfma_f32_16x16x32_bf16 v[144:147], v[96:99], v[80:83], 0
    v_mfma_f32_16x16x32_bf16 v[148:151], v[112:115], v[80:83], 0
    s_waitcnt lgkmcnt(2)
    v_mfma_f32_16x16x32_bf16 v[144:147], v[100:103], v[84:87], v[144:147]
    v_mfma_f32_16x16x32_bf16 v[148:151], v[116:119], v[84:87], v[148:151]
    s_waitcnt lgkmcnt(1)
    v_mfma_f32_16x16x32_bf16 v[144:147], v[104:107], v[88:91], v[144:147]
    v_mfma_f32_16x16x32_bf16 v[148:151], v[120:123], v[88:91], v[148:151]
    s_waitcnt lgkmcnt(0)
    v_mfma_f32_16x16x32_bf16 v[144:147], v[108:111], v[92:95], v[144:147]
    v_mfma_f32_16x16x32_bf16 v[148:151], v[124:127], v[92:95], v[148:151]
    s_nop 6
    v_add_f32_dpp v144, v144, v144 quad_perm:[1,0,3,2] row_mask:0xf bank_mask:0xf
    v_add_f32_dpp v145, v145, v145 quad_perm:[1,0,3,2] row_mask:0xf bank_mask:0xf
    v_add_f32_dpp v146, v146, v146 quad_perm:[1,0,3,2] row_mask:0xf bank_mask:0xf
    v_add_f32_dpp v147, v147, v147 quad_perm:[1,0,3,2] row_mask:0xf bank_mask:0xf
    v_add_f32_dpp v148, v148, v148 quad_perm:[1,0,3,2] row_mask:0xf bank_mask:0xf
    v_add_f32_dpp v149, v149, v149 quad_perm:[1,0,3,2] row_mask:0xf bank_mask:0xf
    v_add_f32_dpp v150, v150, v150 quad_perm:[1,0,3,2] row_mask:0xf bank_mask:0xf
    v_add_f32_dpp v151, v151, v151 quad_perm:[1,0,3,2] row_mask:0xf bank_mask:0xf
    s_mov_b32 exec_lo, 0x000f000f
    s_mov_b32 exec_hi, 0x000f000f
    v_cvt_pk_bf16_f32 v50, v144, v145
    v_cvt_pk_bf16_f32 v51, v146, v147
    v_cvt_pk_bf16_f32 v2, v148, v149
    v_cvt_pk_bf16_f32 v3, v150, v151
    v_cndmask_b32 v50, v50, v2, s[70:71]
    v_cndmask_b32 v51, v51, v3, s[70:71]
    buffer_store_dwordx4 v[48:51], v218, s[8:11], s18 offen
    s_mov_b64 exec, -1
    s_mov_b32 s20, 1
    buffer_load_dwordx4 v[152:155], v219, s[8:11], s19 offen sc1
    s_branch L_Wd_c
L_Wd:
    s_cmp_lg_u32 s20, 6
    s_cbranch_scc1 L_Wd_n
    s_mov_b32 exec_lo, 0x000f000f
    s_mov_b32 exec_hi, 0x000f000f
    buffer_store_dwordx4 v[48:51], v218, s[8:11], s18 offen sc1
    s_mov_b64 exec, -1
L_Wd_n:
    buffer_load_dwordx4 v[152:155], v219, s[8:11], s19 offen sc1
    s_add_u32 s20, s20, 1
    s_cmp_gt_u32 s20, 20000
    s_cbranch_scc1 L_Wd_x
L_Wd_c:
    s_waitcnt vmcnt(0)
    v_cmp_ne_u32 vcc, s42, v152
    s_cbranch_vccnz L_Wd
L_Wd_x:
    s_waitcnt vmcnt(0)
    v_mov_b32_dpp v224, v154 quad_perm:[0,1,2,3] row_mask:0xf bank_mask:0x3
    v_mov_b32_dpp v226, v154 row_ror:8 row_mask:0xf bank_mask:0x3
    v_mov_b32_dpp v228, v154 row_ror:8 row_mask:0xf bank_mask:0xc
    v_mov_b32_dpp v230, v154 quad_perm:[0,1,2,3] row_mask:0xf bank_mask:0xc
    v_mov_b32_dpp v225, v155 quad_perm:[0,1,2,3] row_mask:0xf bank_mask:0x3
    v_mov_b32_dpp v227, v155 row_ror:8 row_mask:0xf bank_mask:0x3
    v_mov_b32_dpp v229, v155 row_ror:8 row_mask:0xf bank_mask:0xc
    v_mov_b32_dpp v231, v155 quad_perm:[0,1,2,3] row_mask:0xf bank_mask:0xc
    s_waitcnt lgkmcnt(0)
    s_nop 0
    v_mfma_f32_16x16x32_bf16 v[200:203], v[224:227], a[0:3], 0
    v_mfma_f32_16x16x32_bf16 v[204:207], v[224:227], a[4:7], 0
    v_mfma_f32_16x16x32_bf16 v[208:211], v[224:227], a[16:19], 0
    v_mfma_f32_16x16x32_bf16 v[212:215], v[224:227], a[20:23], 0
    v_mfma_f32_16x16x32_bf16 v[200:203], v[228:231], a[8:11], v[200:203]
    v_mfma_f32_16x16x32_bf16 v[204:207], v[228:231], a[12:15], v[204:207]
    v_mfma_f32_16x16x32_bf16 v[208:211], v[228:231], a[24:27], v[208:211]
    v_mfma_f32_16x16x32_bf16 v[212:215], v[228:231], a[28:31], v[212:215]
    s_nop 4
    v_pk_add_f32 v[188:189], v[200:201], v[202:203]
    v_pk_add_f32 v[144:145], v[204:205], v[206:207]
    v_pk_add_f32 v[190:191], v[208:209], v[210:211]
    v_pk_add_f32 v[146:147], v[212:213], v[214:215]
    s_nop 0
    v_permlane16_swap_b32 v188, v144
    v_permlane16_swap_b32 v189, v145
    v_permlane16_swap_b32 v190, v146
    v_permlane16_swap_b32 v191, v147
    s_nop 0
    v_pk_add_f32 v[188:189], v[188:189], v[144:145]
    v_pk_add_f32 v[190:191], v[190:191], v[146:147]
    v_cvt_pk_bf16_f32 v192, v188, v189
    v_cvt_pk_bf16_f32 v193, v190, v191
    buffer_store_dwordx4 v[192:195], v25, s[8:11], s39 offen sc1
    s_mov_b64 exec, 1
    buffer_store_dword v48, v196, s[8:11], s62 offen
    s_mov_b64 exec, -1
    s_mov_b32 exec_lo, 0x000f000f
    s_mov_b32 exec_hi, 0x000f000f
    buffer_store_dwordx4 v[48:51], v218, s[8:11], s18 offen sc1
    s_mov_b64 exec, -1
    s_endpgm
L_A2:
    s_load_dword s43, s[8:9], 0
    s_load_dwordx2 s[52:53], s[0:1], 72
    s_load_dwordx2 s[28:29], s[0:1], 40
    s_load_dwordx2 s[60:61], s[0:1], 56
    s_load_dwordx2 s[68:69], s[0:1], 32
    s_load_dwordx2 s[64:65], s[0:1], 64
    s_mov_b32 s14, 2048
    s_mov_b32 s15, 0x20000
    s_mov_b32 s54, 2048
    s_mov_b32 s55, 0x20000
    v_lshlrev_b32 v13, 7, v1
    s_lshl_b32 s34, s6, 10
    s_add_u32 s34, s34, 425984
    v_and_b32 v14, 15, v1
    v_lshrrev_b32 v15, 4, v1
    v_bfe_u32 v16, v1, 2, 2
    v_and_b32 v17, 3, v1
    s_mov_b32 s35, s6
    v_and_b32 v2, 1, v15
    v_lshlrev_b32 v18, 10, v2
    v_lshrrev_b32 v2, 1, v15
    v_lshl_add_u32 v18, v2, 7, v18
    v_and_b32 v2, 1, v1
    v_lshl_add_u32 v18, v2, 1, v18
    s_sub_u32 s56, s4, 16
    s_lshl4_add_u32 s23, s5, s56
    s_lshr_b32 s56, s23, 5
    s_lshl_b32 s26, s56, 8
    s_bfe_u32 s56, s23, 0x20003
    s_lshl_b32 s56, s56, 5
    s_add_u32 s26, s26, s56
    s_and_b32 s56, s23, 7
    s_lshl2_add_u32 s26, s56, s26
    v_add_u32 v2, 0, v15
    v_xor_b32 v2, v2, v14
    v_lshlrev_b32 v2, 4, v2
    v_lshl_add_u32 v2, v14, 10, v2
    v_add_u32 v20, s19, v2
    v_add_u32 v2, 4, v15
    v_xor_b32 v2, v2, v14
    v_lshlrev_b32 v2, 4, v2
    v_lshl_add_u32 v2, v14, 10, v2
    v_add_u32 v21, s19, v2
    v_add_u32 v2, 8, v15
    v_xor_b32 v2, v2, v14
    v_lshlrev_b32 v2, 4, v2
    v_lshl_add_u32 v2, v14, 10, v2
    v_add_u32 v22, s19, v2
    v_add_u32 v2, 12, v15
    v_xor_b32 v2, v2, v14
    v_lshlrev_b32 v2, 4, v2
    v_lshl_add_u32 v2, v14, 10, v2
    v_add_u32 v23, s19, v2
    v_and_b32 v2, 1, v15
    v_lshlrev_b32 v2, 2, v2
    v_add_lshl_u32 v2, v2, v16, 1
    v_lshrrev_b32 v3, 1, v17
    v_xor_b32 v2, v2, v3
    v_lshlrev_b32 v2, 4, v2
    v_and_b32 v3, 1, v1
    v_lshl_add_u32 v2, v3, 3, v2
    v_lshl_add_u32 v3, v15, 2, v16
    v_lshl_add_u32 v2, v3, 11, v2
    s_lshl_b32 s56, s35, 16
    s_lshl_b32 s58, s3, 8
    s_add_u32 s56, s56, s58
    v_add_u32 v2, s56, v2
    v_xor_b32 v24, 0, v2
    v_xor_b32 v3, 16, v2
    v_add_u32 v25, 0x400, v3
    v_xor_b32 v26, 32, v2
    v_xor_b32 v3, 48, v2
    v_add_u32 v27, 0x400, v3
    v_xor_b32 v28, 64, v2
    v_xor_b32 v3, 80, v2
    v_add_u32 v29, 0x400, v3
    v_xor_b32 v30, 96, v2
    v_xor_b32 v3, 112, v2
    v_add_u32 v31, 0x400, v3
    v_xor_b32 v32, 128, v2
    v_xor_b32 v3, 144, v2
    v_add_u32 v33, 0x400, v3
    v_xor_b32 v34, 160, v2
    v_xor_b32 v3, 176, v2
    v_add_u32 v35, 0x400, v3
    v_xor_b32 v36, 192, v2
    v_xor_b32 v3, 208, v2
    v_add_u32 v37, 0x400, v3
    v_xor_b32 v38, 224, v2
    v_xor_b32 v3, 240, v2
    v_add_u32 v39, 0x400, v3
    v_mul_u32_u24 v2, 272, v14
    v_lshrrev_b32 v3, 1, v15
    v_lshl_add_u32 v40, v3, 4, v2
    v_and_b32 v3, 1, v15
    v_lshl_add_u32 v40, v3, 2, v40
    s_lshl_b32 s56, s35, 7
    s_xor_b32 s58, s56, 0x80
    s_lshl_b32 s59, s3, 5
    s_add_u32 s59, s59, 147456
    s_add_u32 s24, s58, s59
    s_add_u32 s59, s56, s59
    v_add_u32 v41, s24, v40
    v_add_u32 v40, s59, v40
    v_lshl_add_u32 v2, v15, 4, v2
    s_add_u32 s56, s56, 147456
    s_add_u32 s58, s58, 147456
    v_add_u32 v42, s56, v2
    v_add_u32 v43, s58, v2
    v_lshlrev_b32 v44, 2, v14
    v_add_u32 v44, 152064, v44
    v_lshlrev_b32 v45, 6, v14
    v_lshl_add_u32 v45, v15, 4, v45
    v_add_u32 v46, 131072, v4
    s_lshl_b32 s30, s3, 12
    s_lshr_b32 s56, s7, 5
    s_lshl1_add_u32 s56, s56, s6
    s_lshl_b32 s56, s56, 14
    s_add_u32 s27, s56, s30
    s_add_u32 s27, s27, 327680
    s_add_u32 s30, s30, 131072
    s_lshl_b32 s31, s6, 14
    s_lshl_b32 s56, s7, 6
    s_add_u32 s31, s31, s56
    s_add_u32 s31, s31, 3670016
    v_add_u32 v47, s30, v4
    v_lshlrev_b32 v48, 12, v16
    v_lshl_add_u32 v48, v17, 4, v48
    s_lshl_b32 s56, s23, 3
    s_add_u32 s56, s56, s3
    s_add_u32 s56, s56, 4
    s_lshl_b32 s56, s56, 12
    v_and_b32 v49, 0xf80, v13
    v_add_u32 v49, s56, v49
    s_mov_b32 s62, 1409024
    s_mov_b32 s63, 0x20000
    s_mov_b32 s66, 1409024
    s_mov_b32 s67, 0x20000
    s_bfe_u32 s56, s4, 0x20002
    s_mul_i32 s58, s5, 3
    s_cmp_lt_u32 s56, 3
    s_cselect_b32 s58, s58, 64
    s_add_u32 s56, s56, s58
    s_and_b32 s58, s4, 3
    s_lshl2_add_u32 s24, s58, s3
    s_mul_i32 s24, s24, 88064
    s_lshl_b32 s25, s56, 7
    s_add_u32 s24, s24, s25
    s_lshl2_add_u32 s25, s56, s58
    s_lshl2_add_u32 s25, s25, s3
    s_lshl_b32 s25, s25, 12
    s_mov_b32 s70, s56
    s_mov_b32 s71, s58
    s_cmp_lt_u32 s56, 22
    s_cselect_b32 s24, s24, 1073741824
    v_lshrrev_b32 v2, 1, v1
    v_mul_u32_u24 v50, 2752, v2
    v_and_b32 v2, 1, v1
    v_mul_u32_u24 v2, 124, v2
    v_add_u32 v50, v50, v2
    v_and_b32 v51, 31, v1
    v_lshlrev_b32 v51, 7, v51
    v_mov_b32 v52, 0
    s_lshl_b32 s38, s23, 7
    s_add_u32 s36, s38, 393216
    s_lshl2_add_u32 s37, s3, s36
    s_add_u32 s38, s38, 409600
    v_and_b32 v2, 1, v1
    v_lshlrev_b32 v72, 6, v2
    v_lshl_add_u32 v72, v15, 4, v72
    s_lshl2_add_u32 s39, s6, s71
    s_lshl_b32 s39, s39, 9
    s_add_u32 s39, s39, 450560
    s_lshr_b32 s58, s23, 2
    s_lshl_b32 s58, s58, 11
    s_add_u32 s58, s58, 458752
    s_lshl_b32 s44, s3, 9
    s_add_u32 s44, s44, s58
    s_lshl_b32 s45, s71, 7
    s_add_u32 s44, s44, s45
    s_lshl_b32 s45, s71, 9
    s_add_u32 s45, s45, s58
    v_mov_b32 v76, 0x3f803f80
    v_mov_b32 v77, 0x3f803f80
    v_mov_b32 v78, 0x3f803f80
    v_mov_b32 v79, 0x3f803f80
    v_mov_b32 v2, 0xff800000
    ds_write_b32 v44, v2
    v_mov_b32 v3, 0
    ds_write_b32 v44, v3 offset:64
    s_waitcnt lgkmcnt(0)
    s_mul_i32 s42, s43, 0x9E3779B1
    s_add_u32 s42, s42, 0x7F4A7C15
    v_xor_b32 v8, 128, v4
    v_xor_b32 v9, 144, v4
    v_xor_b32 v10, 160, v4
    v_xor_b32 v11, 176, v4
    buffer_load_dwordx4 v8, s[48:51], s33 offen offset:0 lds
    buffer_load_dwordx4 v9, s[48:51], s33 offen offset:1024 lds
    buffer_load_dwordx4 v10, s[48:51], s33 offen offset:2048 lds
    buffer_load_dwordx4 v11, s[48:51], s33 offen offset:3072 lds
    s_add_u32 m0, m0, 0x1000
    s_add_u32 s33, s33, 0x1000
    v_xor_b32 v8, 192, v4
    v_xor_b32 v9, 208, v4
    v_xor_b32 v10, 224, v4
    v_xor_b32 v11, 240, v4
    buffer_load_dwordx4 v8, s[48:51], s33 offen offset:0 lds
    buffer_load_dwordx4 v9, s[48:51], s33 offen offset:1024 lds
    buffer_load_dwordx4 v10, s[48:51], s33 offen offset:2048 lds
    buffer_load_dwordx4 v11, s[48:51], s33 offen offset:3072 lds
    s_xor_b32 s58, s19, 0x10000
    s_mov_b32 m0, s58
    s_add_u32 s33, s58, s57
    v_xor_b32 v9, 16, v4
    v_xor_b32 v10, 32, v4
    v_xor_b32 v11, 48, v4
    buffer_load_dwordx4 v4, s[48:51], s33 offen offset:0 lds
    buffer_load_dwordx4 v9, s[48:51], s33 offen offset:1024 lds
    buffer_load_dwordx4 v10, s[48:51], s33 offen offset:2048 lds
    buffer_load_dwordx4 v11, s[48:51], s33 offen offset:3072 lds
    s_add_u32 m0, m0, 0x1000
    s_add_u32 s33, s33, 0x1000
    v_xor_b32 v8, 64, v4
    v_xor_b32 v9, 80, v4
    v_xor_b32 v10, 96, v4
    v_xor_b32 v11, 112, v4
    buffer_load_dwordx4 v8, s[48:51], s33 offen offset:0 lds
    buffer_load_dwordx4 v9, s[48:51], s33 offen offset:1024 lds
    buffer_load_dwordx4 v10, s[48:51], s33 offen offset:2048 lds
    buffer_load_dwordx4 v11, s[48:51], s33 offen offset:3072 lds
    s_add_u32 m0, m0, 0x1000
    s_add_u32 s33, s33, 0x1000
    s_waitcnt vmcnt(8)
    s_barrier
    ds_read_b128 a[0:3], v20 offset:0
    ds_read_b128 a[4:7], v21 offset:0
    ds_read_b128 a[8:11], v22 offset:0
    ds_read_b128 a[12:15], v23 offset:0
    ds_read_b128 a[16:19], v20 offset:256
    ds_read_b128 a[20:23], v21 offset:256
    ds_read_b128 a[24:27], v22 offset:256
    ds_read_b128 a[28:31], v23 offset:256
    ds_read_b128 a[32:35], v20 offset:512
    ds_read_b128 a[36:39], v21 offset:512
    ds_read_b128 a[40:43], v22 offset:512
    ds_read_b128 a[44:47], v23 offset:512
    ds_read_b128 a[48:51], v20 offset:768
    ds_read_b128 a[52:55], v21 offset:768
    ds_read_b128 a[56:59], v22 offset:768
    s_waitcnt lgkmcnt(14)
    ds_read_b128 a[60:63], v23 offset:768
    buffer_load_dword v12, v4, s[8:11], s34 offen sc1
    s_lshl_b32 s46, s5, 8
    s_add_u32 s46, s46, 442368
    v_lshlrev_b32 v81, 2, v1
    buffer_load_dword v80, v81, s[8:11], s46 offen sc1
    v_xor_b32 v8, 128, v4
    v_xor_b32 v9, 144, v4
    v_xor_b32 v10, 160, v4
    v_xor_b32 v11, 176, v4
    buffer_load_dwordx4 v8, s[48:51], s33 offen offset:0 lds
    buffer_load_dwordx4 v9, s[48:51], s33 offen offset:1024 lds
    buffer_load_dwordx4 v10, s[48:51], s33 offen offset:2048 lds
    buffer_load_dwordx4 v11, s[48:51], s33 offen offset:3072 lds
    s_add_u32 m0, m0, 0x1000
    s_add_u32 s33, s33, 0x1000
    v_xor_b32 v8, 192, v4
    v_xor_b32 v9, 208, v4
    v_xor_b32 v10, 224, v4
    v_xor_b32 v11, 240, v4
    buffer_load_dwordx4 v8, s[48:51], s33 offen offset:0 lds
    buffer_load_dwordx4 v9, s[48:51], s33 offen offset:1024 lds
    buffer_load_dwordx4 v10, s[48:51], s33 offen offset:2048 lds
    buffer_load_dwordx4 v11, s[48:51], s33 offen offset:3072 lds
    s_waitcnt lgkmcnt(14)
    ds_read_b64_tr_b16 a[128:129], v24 offset:0
    s_waitcnt lgkmcnt(14)
    ds_read_b64_tr_b16 a[130:131], v25 offset:0
    s_waitcnt lgkmcnt(14)
    ds_read_b64_tr_b16 a[132:133], v26 offset:0
    s_waitcnt lgkmcnt(14)
    ds_read_b64_tr_b16 a[134:135], v27 offset:0
    s_waitcnt lgkmcnt(14)
    ds_read_b64_tr_b16 a[136:137], v28 offset:0
    s_waitcnt lgkmcnt(14)
    ds_read_b64_tr_b16 a[138:139], v29 offset:0
    s_waitcnt lgkmcnt(14)
    ds_read_b64_tr_b16 a[140:141], v30 offset:0
    s_waitcnt lgkmcnt(14)
    ds_read_b64_tr_b16 a[142:143], v31 offset:0
    s_waitcnt lgkmcnt(14)
    ds_read_b64_tr_b16 a[144:145], v32 offset:0
    s_waitcnt lgkmcnt(14)
    ds_read_b64_tr_b16 a[146:147], v33 offset:0
    s_waitcnt lgkmcnt(14)
    ds_read_b64_tr_b16 a[148:149], v34 offset:0
    s_waitcnt lgkmcnt(14)
    ds_read_b64_tr_b16 a[150:151], v35 offset:0
    s_waitcnt lgkmcnt(14)
    ds_read_b64_tr_b16 a[152:153], v36 offset:0
    s_waitcnt lgkmcnt(14)
    ds_read_b64_tr_b16 a[154:155], v37 offset:0
    s_waitcnt lgkmcnt(14)
    ds_read_b64_tr_b16 a[156:157], v38 offset:0
    s_waitcnt lgkmcnt(14)
    ds_read_b64_tr_b16 a[158:159], v39 offset:0
    s_waitcnt lgkmcnt(14)
    ds_read_b64_tr_b16 a[160:161], v24 offset:32768
    s_waitcnt lgkmcnt(14)
    ds_read_b64_tr_b16 a[162:163], v25 offset:32768
    s_waitcnt lgkmcnt(14)
    ds_read_b64_tr_b16 a[164:165], v26 offset:32768
    s_waitcnt lgkmcnt(14)
    ds_read_b64_tr_b16 a[166:167], v27 offset:32768
    s_waitcnt lgkmcnt(14)
    ds_read_b64_tr_b16 a[168:169], v28 offset:32768
    s_waitcnt lgkmcnt(14)
    ds_read_b64_tr_b16 a[170:171], v29 offset:32768
    s_waitcnt lgkmcnt(14)
    ds_read_b64_tr_b16 a[172:173], v30 offset:32768
    s_waitcnt lgkmcnt(14)
    ds_read_b64_tr_b16 a[174:175], v31 offset:32768
    s_waitcnt lgkmcnt(14)
    ds_read_b64_tr_b16 a[176:177], v32 offset:32768
    s_waitcnt lgkmcnt(14)
    ds_read_b64_tr_b16 a[178:179], v33 offset:32768
    s_waitcnt lgkmcnt(14)
    ds_read_b64_tr_b16 a[180:181], v34 offset:32768
    s_waitcnt lgkmcnt(14)
    ds_read_b64_tr_b16 a[182:183], v35 offset:32768
    s_waitcnt lgkmcnt(14)
    ds_read_b64_tr_b16 a[184:185], v36 offset:32768
    s_waitcnt lgkmcnt(14)
    ds_read_b64_tr_b16 a[186:187], v37 offset:32768
    s_waitcnt lgkmcnt(14)
    ds_read_b64_tr_b16 a[188:189], v38 offset:32768
    s_waitcnt lgkmcnt(14)
    ds_read_b64_tr_b16 a[190:191], v39 offset:32768
    v_xor_b32 v20, 0x10000, v20
    v_xor_b32 v21, 0x10000, v21
    v_xor_b32 v22, 0x10000, v22
    v_xor_b32 v23, 0x10000, v23
    v_xor_b32 v24, 0x10000, v24
    v_xor_b32 v25, 0x10000, v25
    v_xor_b32 v26, 0x10000, v26
    v_xor_b32 v27, 0x10000, v27
    v_xor_b32 v28, 0x10000, v28
    v_xor_b32 v29, 0x10000, v29
    v_xor_b32 v30, 0x10000, v30
    v_xor_b32 v31, 0x10000, v31
    v_xor_b32 v32, 0x10000, v32
    v_xor_b32 v33, 0x10000, v33
    v_xor_b32 v34, 0x10000, v34
    v_xor_b32 v35, 0x10000, v35
    v_xor_b32 v36, 0x10000, v36
    v_xor_b32 v37, 0x10000, v37
    v_xor_b32 v38, 0x10000, v38
    v_xor_b32 v39, 0x10000, v39
    s_waitcnt vmcnt(8)
    v_cmp_ne_u32 vcc, s42, v12
    s_cbranch_vccnz L_Af1
L_Af1_x:
    s_mov_b32 m0, s30
    s_mov_b32 s20, 1
    v_cmp_ne_u32 vcc, s42, v80
    s_bcnt1_i32_b64 s58, vcc
    s_cmp_le_u32 s58, 32
    s_cselect_b64 vcc, 0, vcc
    s_cbranch_vccnz L_Aq_l
    buffer_load_dwordx4 v45, s[8:11], s27 offen offset:0 sc1 lds
    buffer_load_dwordx4 v45, s[8:11], s27 offen offset:1024 sc1 lds
    buffer_load_dwordx4 v45, s[8:11], s27 offen offset:2048 sc1 lds
    buffer_load_dwordx4 v45, s[8:11], s27 offen offset:3072 sc1 lds
    s_waitcnt vmcnt(4)
    s_branch L_Aq_m
L_Aq_l:
    s_waitcnt vmcnt(0)
L_Aq_m:
    s_waitcnt lgkmcnt(14)
    ds_read_b128 a[64:67], v20 offset:0
    s_waitcnt lgkmcnt(14)
    ds_read_b128 a[68:71], v21 offset:0
    s_waitcnt lgkmcnt(14)
    ds_read_b128 a[72:75], v22 offset:0
    s_waitcnt lgkmcnt(14)
    ds_read_b128 a[76:79], v23 offset:0
    s_waitcnt lgkmcnt(14)
    ds_read_b128 a[80:83], v20 offset:256
    s_waitcnt lgkmcnt(14)
    ds_read_b128 a[84:87], v21 offset:256
    s_waitcnt lgkmcnt(14)
    ds_read_b128 a[88:91], v22 offset:256
    s_waitcnt lgkmcnt(14)
    ds_read_b128 a[92:95], v23 offset:256
    s_waitcnt lgkmcnt(14)
    ds_read_b128 a[96:99], v20 offset:512
    s_waitcnt lgkmcnt(14)
    ds_read_b128 a[100:103], v21 offset:512
    s_waitcnt lgkmcnt(14)
    ds_read_b128 a[104:107], v22 offset:512
    s_waitcnt lgkmcnt(14)
    ds_read_b128 a[108:111], v23 offset:512
    s_waitcnt lgkmcnt(14)
    ds_read_b128 a[112:115], v20 offset:768
    s_waitcnt lgkmcnt(14)
    ds_read_b128 a[116:119], v21 offset:768
    s_waitcnt lgkmcnt(14)
    ds_read_b128 a[120:123], v22 offset:768
    s_waitcnt lgkmcnt(14)
    ds_read_b128 a[124:127], v23 offset:768
    s_cbranch_vccz L_Aq_n
    s_mov_b32 s20, 0
L_Ahq:
    buffer_load_dword v2, v81, s[8:11], s46 offen offset:0 sc1
    s_add_u32 s20, s20, 1
    s_cmp_gt_u32 s20, HINT_LIMIT
    s_cbranch_scc1 L_Ahq_x
    s_waitcnt vmcnt(0)
    v_cmp_ne_u32 vcc, s42, v2
    s_cbranch_vccnz L_Ahq
L_Ahq_x:
    s_mov_b32 s20, 1
    buffer_load_dwordx4 v45, s[8:11], s27 offen offset:0 sc1 lds
    buffer_load_dwordx4 v45, s[8:11], s27 offen offset:1024 sc1 lds
    buffer_load_dwordx4 v45, s[8:11], s27 offen offset:2048 sc1 lds
    buffer_load_dwordx4 v45, s[8:11], s27 offen offset:3072 sc1 lds
L_Aq_n:
    s_barrier
    s_waitcnt lgkmcnt(14)
    ds_read_b64_tr_b16 a[192:193], v24 offset:0
    s_waitcnt lgkmcnt(14)
    ds_read_b64_tr_b16 a[194:195], v25 offset:0
    s_waitcnt lgkmcnt(14)
    ds_read_b64_tr_b16 a[196:197], v26 offset:0
    s_waitcnt lgkmcnt(14)
    ds_read_b64_tr_b16 a[198:199], v27 offset:0
    s_waitcnt lgkmcnt(14)
    ds_read_b64_tr_b16 a[200:201], v28 offset:0
    s_waitcnt lgkmcnt(14)
    ds_read_b64_tr_b16 a[202:203], v29 offset:0
    s_waitcnt lgkmcnt(14)
    ds_read_b64_tr_b16 a[204:205], v30 offset:0
    s_waitcnt lgkmcnt(14)
    ds_read_b64_tr_b16 a[206:207], v31 offset:0
    s_waitcnt lgkmcnt(14)
    ds_read_b64_tr_b16 a[208:209], v32 offset:0
    s_waitcnt lgkmcnt(14)
    ds_read_b64_tr_b16 a[210:211], v33 offset:0
    s_waitcnt lgkmcnt(14)
    ds_read_b64_tr_b16 a[212:213], v34 offset:0
    s_waitcnt lgkmcnt(14)
    ds_read_b64_tr_b16 a[214:215], v35 offset:0
    s_waitcnt lgkmcnt(14)
    ds_read_b64_tr_b16 a[216:217], v36 offset:0
    s_waitcnt lgkmcnt(14)
    ds_read_b64_tr_b16 a[218:219], v37 offset:0
    s_waitcnt lgkmcnt(14)
    ds_read_b64_tr_b16 a[220:221], v38 offset:0
    s_waitcnt lgkmcnt(13)
    ds_read_b64_tr_b16 a[222:223], v39 offset:0
    ds_read_b64_tr_b16 a[224:225], v24 offset:32768
    s_waitcnt lgkmcnt(13)
    ds_read_b64_tr_b16 a[226:227], v25 offset:32768
    ds_read_b64_tr_b16 a[228:229], v26 offset:32768
    s_waitcnt lgkmcnt(13)
    ds_read_b64_tr_b16 a[230:231], v27 offset:32768
    ds_read_b64_tr_b16 a[232:233], v28 offset:32768
    s_waitcnt lgkmcnt(13)
    ds_read_b64_tr_b16 a[234:235], v29 offset:32768
    ds_read_b64_tr_b16 a[236:237], v30 offset:32768
    s_waitcnt lgkmcnt(13)
    ds_read_b64_tr_b16 a[238:239], v31 offset:32768
    ds_read_b64_tr_b16 a[240:241], v32 offset:32768
    s_waitcnt lgkmcnt(13)
    ds_read_b64_tr_b16 a[242:243], v33 offset:32768
    ds_read_b64_tr_b16 a[244:245], v34 offset:32768
    s_waitcnt lgkmcnt(13)
    ds_read_b64_tr_b16 a[246:247], v35 offset:32768
    ds_read_b64_tr_b16 a[248:249], v36 offset:32768
    s_waitcnt lgkmcnt(13)
    ds_read_b64_tr_b16 a[250:251], v37 offset:32768
    ds_read_b64_tr_b16 a[252:253], v38 offset:32768
    s_waitcnt lgkmcnt(13)
    ds_read_b64_tr_b16 a[254:255], v39 offset:32768
    s_branch L_Aq_c
L_Aq:
    s_mov_b32 s58, 0
L_Ahq2:
    buffer_load_dword v2, v81, s[8:11], s46 offen offset:0 sc1
    s_add_u32 s58, s58, 1
    s_cmp_gt_u32 s58, HINT_LIMIT
    s_cbranch_scc1 L_Ahq2_x
    s_waitcnt vmcnt(0)
    v_cmp_ne_u32 vcc, s42, v2
    s_cbranch_vccnz L_Ahq2
L_Ahq2_x:
    buffer_load_dwordx4 v45, s[8:11], s27 offen offset:0 sc1 lds
    buffer_load_dwordx4 v45, s[8:11], s27 offen offset:1024 sc1 lds
    buffer_load_dwordx4 v45, s[8:11], s27 offen offset:2048 sc1 lds
    buffer_load_dwordx4 v45, s[8:11], s27 offen offset:3072 sc1 lds
L_Aq_c:
    s_add_u32 s20, s20, 1
    s_cmp_gt_u32 s20, 20000
    s_cbranch_scc1 L_Aq_y
    s_waitcnt vmcnt(0) lgkmcnt(8)
    ds_read_b128 v[84:87], v47 offset:0
    ds_read_b128 v[88:91], v47 offset:1024
    ds_read_b128 v[92:95], v47 offset:2048
    ds_read_b128 v[96:99], v47 offset:3072
    s_waitcnt lgkmcnt(0)
    v_max3_u32 v148, v87, v91, v95
    v_max_u32 v148, v148, v99
    v_cmp_eq_u32 vcc, -1, v148
    s_cbranch_vccnz L_Aq
L_Aq_y:
    s_waitcnt vmcnt(0) lgkmcnt(0)
L_Aq_x:
    s_barrier
    ds_read_b128 v[84:87], v46 offset:0
    ds_read_b128 v[88:91], v46 offset:1024
    ds_read_b128 v[92:95], v46 offset:2048
    ds_read_b128 v[96:99], v46 offset:3072
    ds_read_b128 v[100:103], v46 offset:4096
    ds_read_b128 v[104:107], v46 offset:5120
    ds_read_b128 v[108:111], v46 offset:6144
    ds_read_b128 v[112:115], v46 offset:7168
    ds_read_b128 v[116:119], v46 offset:8192
    ds_read_b128 v[120:123], v46 offset:9216
    buffer_load_dword v254, v52, s[8:11], s44 offen
    global_load_dword v255, v49, s[28:29]
    s_mov_b32 s56, 0x3e0293ee
    s_waitcnt lgkmcnt(9)
    v_mfma_f32_16x16x32_bf16 v[152:155], a[0:3], v[84:87], 0
    ds_read_b128 v[124:127], v46 offset:10240
    s_waitcnt lgkmcnt(9)
    v_mfma_f32_16x16x32_bf16 v[152:155], a[4:7], v[88:91], v[152:155]
    ds_read_b128 v[128:131], v46 offset:11264
    s_waitcnt lgkmcnt(9)
    v_mfma_f32_16x16x32_bf16 v[152:155], a[8:11], v[92:95], v[152:155]
    ds_read_b128 v[132:135], v46 offset:12288
    s_waitcnt lgkmcnt(9)
    v_mfma_f32_16x16x32_bf16 v[152:155], a[12:15], v[96:99], v[152:155]
    ds_read_b128 v[136:139], v46 offset:13312
    s_waitcnt lgkmcnt(9)
    v_mfma_f32_16x16x32_bf16 v[152:155], a[16:19], v[100:103], v[152:155]
    ds_read_b128 v[140:143], v46 offset:14336
    s_waitcnt lgkmcnt(9)
    v_mfma_f32_16x16x32_bf16 v[152:155], a[20:23], v[104:107], v[152:155]
    ds_read_b128 v[144:147], v46 offset:15360
    s_waitcnt lgkmcnt(9)
    v_mfma_f32_16x16x32_bf16 v[152:155], a[24:27], v[108:111], v[152:155]
    s_waitcnt lgkmcnt(8)
    v_mfma_f32_16x16x32_bf16 v[152:155], a[28:31], v[112:115], v[152:155]
    s_waitcnt lgkmcnt(7)
    v_mfma_f32_16x16x32_bf16 v[152:155], a[32:35], v[116:119], v[152:155]
    s_waitcnt lgkmcnt(6)
    v_mfma_f32_16x16x32_bf16 v[152:155], a[36:39], v[120:123], v[152:155]
    s_waitcnt lgkmcnt(5)
    v_mfma_f32_16x16x32_bf16 v[152:155], a[40:43], v[124:127], v[152:155]
    s_waitcnt lgkmcnt(4)
    v_mfma_f32_16x16x32_bf16 v[152:155], a[44:47], v[128:131], v[152:155]
    s_waitcnt lgkmcnt(3)
    v_mfma_f32_16x16x32_bf16 v[152:155], a[48:51], v[132:135], v[152:155]
    s_waitcnt lgkmcnt(2)
    v_mfma_f32_16x16x32_bf16 v[152:155], a[52:55], v[136:139], v[152:155]
    s_waitcnt lgkmcnt(1)
    v_mfma_f32_16x16x32_bf16 v[152:155], a[56:59], v[140:143], v[152:155]
    s_waitcnt lgkmcnt(0)
    v_mfma_f32_16x16x32_bf16 v[152:155], a[60:63], v[144:147], v[152:155]
    v_mfma_f32_16x16x32_bf16 v[156:159], a[64:67], v[84:87], 0
    v_mfma_f32_16x16x32_bf16 v[156:159], a[68:71], v[88:91], v[156:159]
    v_mfma_f32_16x16x32_bf16 v[156:159], a[72:75], v[92:95], v[156:159]
    s_nop 4
    v_max3_f32 v240, v152, v153, v154
    v_mfma_f32_16x16x32_bf16 v[156:159], a[76:79], v[96:99], v[156:159]
    v_max_f32 v240, v240, v155
    ds_max_f32 v44, v240
    v_mfma_f32_16x16x32_bf16 v[156:159], a[80:83], v[100:103], v[156:159]
    v_mfma_f32_16x16x32_bf16 v[156:159], a[84:87], v[104:107], v[156:159]
    v_mfma_f32_16x16x32_bf16 v[156:159], a[88:91], v[108:111], v[156:159]
    s_waitcnt lgkmcnt(0)
    s_barrier
    ds_read_b32 v240, v44
    v_mfma_f32_16x16x32_bf16 v[156:159], a[92:95], v[112:115], v[156:159]
    v_mfma_f32_16x16x32_bf16 v[156:159], a[96:99], v[116:119], v[156:159]
    v_mfma_f32_16x16x32_bf16 v[156:159], a[100:103], v[120:123], v[156:159]
    s_waitcnt lgkmcnt(0)
    v_mul_f32 v236, s56, v240
    v_mfma_f32_16x16x32_bf16 v[156:159], a[104:107], v[124:127], v[156:159]
    v_fma_f32 v228, v152, s56, -v236
    v_fma_f32 v229, v153, s56, -v236
    v_mfma_f32_16x16x32_bf16 v[156:159], a[108:111], v[128:131], v[156:159]
    v_fma_f32 v230, v154, s56, -v236
    v_fma_f32 v231, v155, s56, -v236
    v_mfma_f32_16x16x32_bf16 v[156:159], a[112:115], v[132:135], v[156:159]
    v_exp_f32 v228, v228
    v_mfma_f32_16x16x32_bf16 v[156:159], a[116:119], v[136:139], v[156:159]
    v_exp_f32 v229, v229
    v_mfma_f32_16x16x32_bf16 v[156:159], a[120:123], v[140:143], v[156:159]
    v_exp_f32 v230, v230
    v_mfma_f32_16x16x32_bf16 v[156:159], a[124:127], v[144:147], v[156:159]
    v_exp_f32 v231, v231
    v_mov_b32 v238, s42
    v_cvt_pk_bf16_f32 v212, v228, v230
    v_cvt_pk_bf16_f32 v213, v229, v231
    ds_write2_b32 v40, v212, v213 offset1:2
    s_mov_b32 s57, 0x42200000
    s_nop 1
    v_fma_f32 v232, v156, s56, -v236
    v_fma_f32 v233, v157, s56, -v236
    v_fma_f32 v234, v158, s56, -v236
    v_fma_f32 v235, v159, s56, -v236
    v_max3_f32 v241, v232, v233, v234
    v_exp_f32 v232, v232
    v_max_f32 v241, v241, v235
    v_exp_f32 v233, v233
    v_cmp_lt_f32 vcc, s57, v241
    v_exp_f32 v234, v234
    v_exp_f32 v235, v235
    s_cbranch_vccnz L_Aovf
L_Aovf_x:
    v_cvt_pk_bf16_f32 v214, v232, v234
    v_cvt_pk_bf16_f32 v215, v233, v235
    ds_write2_b32 v41, v214, v215 offset1:2
    s_waitcnt lgkmcnt(0)
    s_barrier
L_Apv:
    ds_read_b32 v241, v44 offset:64
    ds_read_b128 v[192:195], v42 offset:0
    ds_read_b128 v[196:199], v42 offset:64
    ds_read_b128 v[200:203], v43 offset:0
    ds_read_b128 v[204:207], v43 offset:64
    s_waitcnt lgkmcnt(4)
    v_cmp_ne_u32 vcc, 0, v241
    s_cbranch_vccnz L_Aslow
    s_cmp_lg_u32 s3, 3
    s_cbranch_scc1 L_Anol
    s_waitcnt lgkmcnt(0)
    v_mfma_f32_16x16x32_bf16 v[208:211], v[76:79], v[192:195], 0
    v_mfma_f32_16x16x32_bf16 v[208:211], v[76:79], v[196:199], v[208:211]
    v_mfma_f32_16x16x32_bf16 v[208:211], v[76:79], v[200:203], v[208:211]
    v_mfma_f32_16x16x32_bf16 v[208:211], v[76:79], v[204:207], v[208:211]
L_Anol:
    s_waitcnt lgkmcnt(3)
    v_mfma_f32_16x16x32_bf16 v[160:163], a[128:131], v[192:195], 0
    v_mfma_f32_16x16x32_bf16 v[164:167], a[132:135], v[192:195], 0
    s_waitcnt lgkmcnt(2)
    v_mfma_f32_16x16x32_bf16 v[160:163], a[160:163], v[196:199], v[160:163]
    v_mfma_f32_16x16x32_bf16 v[164:167], a[164:167], v[196:199], v[164:167]
    s_waitcnt lgkmcnt(1)
    v_mfma_f32_16x16x32_bf16 v[160:163], a[192:195], v[200:203], v[160:163]
    v_mfma_f32_16x16x32_bf16 v[164:167], a[196:199], v[200:203], v[164:167]
    s_waitcnt lgkmcnt(0)
    v_mfma_f32_16x16x32_bf16 v[160:163], a[224:227], v[204:207], v[160:163]
    v_mfma_f32_16x16x32_bf16 v[164:167], a[228:231], v[204:207], v[164:167]
    s_cmp_lg_u32 s3, 3
    s_cbranch_scc1 L_Anos
    v_mov_b32 v237, v208
    s_mov_b64 exec, 0xffff
    buffer_store_dwordx4 v[236:239], v48, s[8:11], s31 offen sc1
    s_mov_b64 exec, 1
    buffer_store_dword v238, v52, s[8:11], s36 offen
    s_mov_b64 exec, -1
L_Anos:
    v_mfma_f32_16x16x32_bf16 v[168:171], a[136:139], v[192:195], 0
    v_mfma_f32_16x16x32_bf16 v[172:175], a[140:143], v[192:195], 0
    v_mfma_f32_16x16x32_bf16 v[168:171], a[168:171], v[196:199], v[168:171]
    v_mfma_f32_16x16x32_bf16 v[172:175], a[172:175], v[196:199], v[172:175]
    s_nop 1
    v_cvt_pk_bf16_f32 v212, v160, v161
    v_mfma_f32_16x16x32_bf16 v[168:171], a[200:203], v[200:203], v[168:171]
    v_cvt_pk_bf16_f32 v213, v162, v163
    v_mfma_f32_16x16x32_bf16 v[172:175], a[204:207], v[200:203], v[172:175]
    v_cvt_pk_bf16_f32 v214, v164, v165
    v_mfma_f32_16x16x32_bf16 v[168:171], a[232:235], v[204:207], v[168:171]
    v_cvt_pk_bf16_f32 v215, v166, v167
    v_mfma_f32_16x16x32_bf16 v[172:175], a[236:239], v[204:207], v[172:175]
    buffer_store_dwordx4 v[212:215], v7, s[8:11], s18 offen offset:0 sc1
    v_mfma_f32_16x16x32_bf16 v[176:179], a[144:147], v[192:195], 0
    v_mfma_f32_16x16x32_bf16 v[180:183], a[148:151], v[192:195], 0
    v_mfma_f32_16x16x32_bf16 v[176:179], a[176:179], v[196:199], v[176:179]
    v_mfma_f32_16x16x32_bf16 v[180:183], a[180:183], v[196:199], v[180:183]
    s_nop 1
    v_cvt_pk_bf16_f32 v216, v168, v169
    v_mfma_f32_16x16x32_bf16 v[176:179], a[208:211], v[200:203], v[176:179]
    v_cvt_pk_bf16_f32 v217, v170, v171
    v_mfma_f32_16x16x32_bf16 v[180:183], a[212:215], v[200:203], v[180:183]
    v_cvt_pk_bf16_f32 v218, v172, v173
    v_mfma_f32_16x16x32_bf16 v[176:179], a[240:243], v[204:207], v[176:179]
    v_cvt_pk_bf16_f32 v219, v174, v175
    v_mfma_f32_16x16x32_bf16 v[180:183], a[244:247], v[204:207], v[180:183]
    buffer_store_dwordx4 v[216:219], v7, s[8:11], s18 offen offset:128 sc1
    s_mov_b64 exec, 1
    buffer_store_dword v238, v52, s[8:11], s37 offen offset:16
    s_mov_b64 exec, -1
    v_mfma_f32_16x16x32_bf16 v[184:187], a[152:155], v[192:195], 0
    v_mfma_f32_16x16x32_bf16 v[188:191], a[156:159], v[192:195], 0
    v_mfma_f32_16x16x32_bf16 v[184:187], a[184:187], v[196:199], v[184:187]
    v_mfma_f32_16x16x32_bf16 v[188:191], a[188:191], v[196:199], v[188:191]
    s_nop 1
    v_cvt_pk_bf16_f32 v220, v176, v177
    v_mfma_f32_16x16x32_bf16 v[184:187], a[216:219], v[200:203], v[184:187]
    v_cvt_pk_bf16_f32 v221, v178, v179
    v_mfma_f32_16x16x32_bf16 v[188:191], a[220:223], v[200:203], v[188:191]
    v_cvt_pk_bf16_f32 v222, v180, v181
    v_mfma_f32_16x16x32_bf16 v[184:187], a[248:251], v[204:207], v[184:187]
    v_cvt_pk_bf16_f32 v223, v182, v183
    v_mfma_f32_16x16x32_bf16 v[188:191], a[252:255], v[204:207], v[188:191]
    buffer_store_dwordx4 v[220:223], v7, s[8:11], s18 offen offset:256 sc1
    s_nop 4
    v_cvt_pk_bf16_f32 v224, v184, v185
    v_cvt_pk_bf16_f32 v225, v186, v187
    v_cvt_pk_bf16_f32 v226, v188, v189
    v_cvt_pk_bf16_f32 v227, v190, v191
    buffer_store_dwordx4 v[224:227], v7, s[8:11], s18 offen offset:384 sc1
    v_lshrrev_b32 v2, 3, v1
    v_mul_u32_u24 v36, 2752, v2
    v_and_b32 v2, 7, v1
    v_lshl_add_u32 v36, v2, 4, v36
    v_lshlrev_b32 v38, 6, v2
    v_lshl_add_u32 v38, v15, 4, v38
    v_lshlrev_b32 v2, 1, v15
    v_xor_b32 v2, v2, v14
    v_lshlrev_b32 v2, 4, v2
    v_lshl_add_u32 v32, v15, 10, v2
    v_xor_b32 v3, 0x80, v32
    v_add_u32 v33, 3072, v3
    v_add_u32 v34, 6144, v32
    v_add_u32 v35, 9216, v3
    s_lshl_b32 s59, s3, 12
    s_lshl_b32 s58, s35, 16
    s_add_u32 s59, s59, s58
    s_mov_b32 m0, s59
    s_lshl2_add_u32 s25, s70, s71
    s_lshl_b32 s32, s25, 14
    s_lshl_b32 s33, s3, 8
    s_add_u32 s32, s32, s33
    s_cmp_ge_u32 s70, 22
    s_cbranch_scc1 L_Anf1
    buffer_load_dwordx4 v[56:59], v72, s[8:11], s39 offen offset:0 sc1
    buffer_load_dwordx4 v[60:63], v72, s[8:11], s39 offen offset:128 sc1
    buffer_load_dwordx4 v[64:67], v72, s[8:11], s39 offen offset:256 sc1
    buffer_load_dwordx4 v[68:71], v72, s[8:11], s39 offen offset:384 sc1
    buffer_load_dwordx4 v36, s[60:63], s24 offen lds
    s_add_u32 m0, m0, 0x400
    s_add_u32 s24, s24, 22016
    buffer_load_dwordx4 v36, s[60:63], s24 offen lds
    s_add_u32 m0, m0, 0x400
    s_add_u32 s24, s24, 22016
    buffer_load_dwordx4 v36, s[60:63], s24 offen lds
    s_add_u32 m0, m0, 0x400
    s_add_u32 s24, s24, 22016
    buffer_load_dwordx4 v36, s[60:63], s24 offen lds
    s_add_u32 m0, s59, 16384
    s_nop 0
    buffer_load_dwordx4 v32, s[64:67], s32 offen offset:0 lds
    buffer_load_dwordx4 v33, s[64:67], s32 offen offset:1024 lds
    buffer_load_dwordx4 v34, s[64:67], s32 offen offset:2048 lds
    buffer_load_dwordx4 v35, s[64:67], s32 offen offset:3072 lds
L_Anf1:
    s_cmp_ge_u32 s70, 22
    s_cbranch_scc1 L_Anf2
    v_lshl_add_u32 v37, v15, 3, v16
    v_lshlrev_b32 v37, 7, v37
    v_lshl_add_u32 v37, v17, 3, v37
    s_lshl_b32 s58, s3, 5
    v_add_u32 v37, s58, v37
    s_lshl_b32 s58, s35, 16
    v_add_u32 v37, s58, v37
    v_and_b32 v2, 1, v15
    v_lshl_or_b32 v2, v2, 2, v16
    v_lshlrev_b32 v2, 5, v2
    v_lshl_or_b32 v2, v17, 3, v2
    v_lshl_add_u32 v3, v15, 2, v16
    v_lshlrev_b32 v3, 8, v3
    s_add_u32 s58, s59, 16384
    v_add_u32 v3, s58, v3
    v_xor_b32 v24, 0, v2
    v_add_u32 v24, v24, v3
    v_xor_b32 v25, 32, v2
    v_add_u32 v25, v25, v3
    v_xor_b32 v26, 64, v2
    v_add_u32 v26, v26, v3
    v_xor_b32 v27, 96, v2
    v_add_u32 v27, v27, v3
    v_xor_b32 v28, 128, v2
    v_add_u32 v28, v28, v3
    v_xor_b32 v29, 160, v2
    v_add_u32 v29, v29, v3
    v_xor_b32 v30, 192, v2
    v_add_u32 v30, v30, v3
    v_xor_b32 v31, 224, v2
    v_add_u32 v31, v31, v3
    v_lshrrev_b32 v39, 1, v1
    v_mul_u32_u24 v39, 7168, v39
    v_and_b32 v2, 1, v1
    v_lshl_or_b32 v39, v2, 4, v39
    s_lshl_b32 s25, s25, 5
    s_mul_i32 s58, s3, 229376
    s_add_u32 s25, s25, s58
    s_add_u32 s25, s25, 4198400
    v_mov_b32 v210, s42
    buffer_load_dword v254, v39, s[8:11], s25 offen
    s_waitcnt vmcnt(5)
    s_barrier
    ds_read_b64_tr_b16 v[100:101], v37 offset:0
    ds_read_b64_tr_b16 v[102:103], v37 offset:512
    ds_read_b64_tr_b16 v[104:105], v37 offset:4096
    ds_read_b64_tr_b16 v[106:107], v37 offset:4608
    ds_read_b64_tr_b16 v[108:109], v37 offset:8192
    ds_read_b64_tr_b16 v[110:111], v37 offset:8704
    ds_read_b64_tr_b16 v[112:113], v37 offset:12288
    ds_read_b64_tr_b16 v[114:115], v37 offset:12800
    s_waitcnt lgkmcnt(6)
    v_mfma_f32_16x16x32_bf16 v[152:155], v[100:103], v[56:59], 0
    s_waitcnt lgkmcnt(4)
    v_mfma_f32_16x16x32_bf16 v[152:155], v[104:107], v[60:63], v[152:155]
    s_waitcnt lgkmcnt(2)
    v_mfma_f32_16x16x32_bf16 v[152:155], v[108:111], v[64:67], v[152:155]
    s_waitcnt lgkmcnt(0)
    v_mfma_f32_16x16x32_bf16 v[152:155], v[112:115], v[68:71], v[152:155]
    s_mov_b32 exec_lo, 0x00030003
    s_mov_b32 exec_hi, 0x00030003
    s_nop 5
    v_cvt_pk_bf16_f32 v208, v152, v153
    v_cvt_pk_bf16_f32 v209, v154, v155
    buffer_store_dwordx4 v[208:211], v38, s[8:11], s44 offen
    s_mov_b64 exec, -1
    s_mov_b32 s20, 0
L_Ah:
    s_cmp_lg_u32 s20, 6
    s_cbranch_scc1 L_Ah_n
    s_mov_b32 exec_lo, 0x00030003
    s_mov_b32 exec_hi, 0x00030003
    buffer_store_dwordx4 v[208:211], v38, s[8:11], s44 offen sc1
    s_mov_b64 exec, -1
L_Ah_n:
    buffer_load_dwordx3 v[136:138], v38, s[8:11], s45 offen sc1
    s_add_u32 s20, s20, 1
    s_cmp_gt_u32 s20, 20000
    s_cbranch_scc1 L_Ah_x
    s_waitcnt vmcnt(0)
    v_cmp_ne_u32 vcc, s42, v138
    s_cbranch_vccnz L_Ah
L_Ah_x:
    s_waitcnt vmcnt(0)
    s_mov_b32 exec_lo, 0x00030003
    s_mov_b32 exec_hi, 0x00030003
    buffer_store_dwordx4 v[208:211], v38, s[8:11], s44 offen sc1
    s_mov_b64 exec, -1
    ds_read_b64_tr_b16 v[116:117], v24
    ds_read_b64_tr_b16 v[118:119], v25
    ds_read_b64_tr_b16 v[120:121], v26
    ds_read_b64_tr_b16 v[122:123], v27
    ds_read_b64_tr_b16 v[124:125], v28
    ds_read_b64_tr_b16 v[126:127], v29
    ds_read_b64_tr_b16 v[128:129], v30
    ds_read_b64_tr_b16 v[130:131], v31
    v_lshlrev_b32 v132, 16, v136
    v_and_b32 v133, 0xffff0000, v136
    v_lshlrev_b32 v134, 16, v137
    v_and_b32 v135, 0xffff0000, v137
    v_add_f32_dpp v132, v132, v132 quad_perm:[2,3,0,1] row_mask:0xf bank_mask:0xf
    v_add_f32_dpp v133, v133, v133 quad_perm:[2,3,0,1] row_mask:0xf bank_mask:0xf
    v_add_f32_dpp v134, v134, v134 quad_perm:[2,3,0,1] row_mask:0xf bank_mask:0xf
    v_add_f32_dpp v135, v135, v135 quad_perm:[2,3,0,1] row_mask:0xf bank_mask:0xf
    v_add_f32_dpp v132, v132, v132 row_ror:4 row_mask:0xf bank_mask:0xf
    v_add_f32_dpp v133, v133, v133 row_ror:4 row_mask:0xf bank_mask:0xf
    v_add_f32_dpp v134, v134, v134 row_ror:4 row_mask:0xf bank_mask:0xf
    v_add_f32_dpp v135, v135, v135 row_ror:4 row_mask:0xf bank_mask:0xf
    v_cvt_pk_bf16_f32 v136, v132, v133
    v_cvt_pk_bf16_f32 v137, v134, v135
    v_lshlrev_b32 v132, 16, v136
    v_and_b32 v133, 0xffff0000, v136
    v_lshlrev_b32 v134, 16, v137
    v_and_b32 v135, 0xffff0000, v137
    v_mul_f32 v140, 0xbfb8aa3b, v132
    v_mul_f32 v141, 0xbfb8aa3b, v133
    v_mul_f32 v142, 0xbfb8aa3b, v134
    v_mul_f32 v143, 0xbfb8aa3b, v135
    v_exp_f32 v140, v140
    v_exp_f32 v141, v141
    v_exp_f32 v142, v142
    v_exp_f32 v143, v143
    s_nop 0
    v_add_f32 v140, 1.0, v140
    v_add_f32 v141, 1.0, v141
    v_add_f32 v142, 1.0, v142
    v_add_f32 v143, 1.0, v143
    v_rcp_f32 v140, v140
    v_rcp_f32 v141, v141
    v_rcp_f32 v142, v142
    v_rcp_f32 v143, v143
    s_nop 0
    v_mul_f32 v132, v132, v140
    v_mul_f32 v133, v133, v141
    v_mul_f32 v134, v134, v142
    v_mul_f32 v135, v135, v143
    v_cvt_pk_bf16_f32 v136, v132, v133
    v_cvt_pk_bf16_f32 v137, v134, v135
    s_mov_b32 s56, 0x00030003
    s_mov_b32 s57, s56
    s_lshl_b64 s[58:59], s[56:57], 8
    v_cndmask_b32 v228, 0, v136, s[56:57]
    v_cndmask_b32 v230, 0, v136, s[58:59]
    v_cndmask_b32 v229, 0, v137, s[56:57]
    v_cndmask_b32 v231, 0, v137, s[58:59]
    s_waitcnt lgkmcnt(0)
    v_mfma_f32_16x16x16_bf16 v[160:163], v[228:229], v[116:117], 0
    v_mfma_f32_16x16x16_bf16 v[164:167], v[228:229], v[118:119], 0
    v_mfma_f32_16x16x16_bf16 v[168:171], v[228:229], v[124:125], 0
    v_mfma_f32_16x16x16_bf16 v[172:175], v[228:229], v[126:127], 0
    v_mfma_f32_16x16x16_bf16 v[160:163], v[230:231], v[120:121], v[160:163]
    v_mfma_f32_16x16x16_bf16 v[164:167], v[230:231], v[122:123], v[164:167]
    v_mfma_f32_16x16x16_bf16 v[168:171], v[230:231], v[128:129], v[168:171]
    v_mfma_f32_16x16x16_bf16 v[172:175], v[230:231], v[130:131], v[172:175]
    s_nop 4
    v_pk_add_f32 v[212:213], v[160:161], v[162:163]
    v_pk_add_f32 v[216:217], v[164:165], v[166:167]
    v_pk_add_f32 v[214:215], v[168:169], v[170:171]
    v_pk_add_f32 v[218:219], v[172:173], v[174:175]
    s_nop 0
    v_permlane16_swap_b32 v212, v216
    v_permlane16_swap_b32 v213, v217
    v_permlane16_swap_b32 v214, v218
    v_permlane16_swap_b32 v215, v219
    s_nop 0
    v_pk_add_f32 v[212:213], v[212:213], v[216:217]
    v_pk_add_f32 v[214:215], v[214:215], v[218:219]
    v_cvt_pk_bf16_f32 v208, v212, v213
    v_cvt_pk_bf16_f32 v209, v214, v215
    buffer_store_dwordx4 v[208:211], v39, s[8:11], s25 offen sc1
L_Anf2:
    s_lshl2_add_u32 s58, s23, s3
    s_lshl_b32 s58, s58, 3
    s_add_u32 s58, s58, 409604
    s_mov_b64 exec, 1
    buffer_store_dword v238, v52, s[8:11], s58 offen
    s_mov_b64 exec, -1
    s_cmp_lg_u32 s3, 0
    s_cbranch_scc1 L_Aend0
    s_mul_i32 s56, s23, 7168
    s_add_u32 s56, s56, 4194304
    s_add_u32 s57, s56, 0x1000
    buffer_load_ushort v19, v18, s[12:15], s26 offen
    v_mov_b32 v140, 0
    v_mov_b32 v141, 0
    v_mov_b32 v142, s42
    s_lshl_b32 s38, s5, 9
    s_add_u32 s38, s38, 409600
    v_lshlrev_b32 v81, 3, v1
    s_mov_b32 s40, s42
    s_mov_b32 s41, s42
    s_mov_b32 s20, 0
L_Rh:
    buffer_load_dwordx2 v[2:3], v81, s[8:11], s38 offen sc1
    s_add_u32 s20, s20, 1
    s_cmp_gt_u32 s20, HINT_LIMIT
    s_cbranch_scc1 L_Rh_x
    s_waitcnt vmcnt(0)
    v_cmp_ne_u64 vcc, s[40:41], v[2:3]
    s_cbranch_vccnz L_Rh
L_Rh_x:
    s_mov_b32 s20, 0
L_R:
    buffer_load_dwordx3 v[116:118], v4, s[8:11], s56 offen offset:0 sc1
    buffer_load_dwordx3 v[120:122], v4, s[8:11], s56 offen offset:1024 sc1
    buffer_load_dwordx3 v[124:126], v4, s[8:11], s56 offen offset:2048 sc1
    buffer_load_dwordx3 v[128:130], v4, s[8:11], s56 offen offset:3072 sc1
    buffer_load_dwordx3 v[132:134], v4, s[8:11], s57 offen offset:0 sc1
    buffer_load_dwordx3 v[136:138], v4, s[8:11], s57 offen offset:1024 sc1
    s_mov_b32 exec_hi, 0xffff
    buffer_load_dwordx3 v[140:142], v4, s[8:11], s57 offen offset:2048 sc1
    s_mov_b32 exec_hi, -1
    s_add_u32 s20, s20, 1
    s_cmp_gt_u32 s20, 20000
    s_cbranch_scc1 L_R_x
    s_waitcnt vmcnt(6)
    v_sad_u32 v148, v118, s42, 0
    v_lshlrev_b32 v84, 16, v116
    v_and_b32 v85, 0xffff0000, v116
    v_lshlrev_b32 v86, 16, v117
    v_and_b32 v87, 0xffff0000, v117
    s_waitcnt vmcnt(5)
    v_sad_u32 v148, v122, s42, v148
    v_lshlrev_b32 v88, 16, v120
    v_and_b32 v89, 0xffff0000, v120
    v_lshlrev_b32 v90, 16, v121
    v_and_b32 v91, 0xffff0000, v121
    s_waitcnt vmcnt(4)
    v_sad_u32 v148, v126, s42, v148
    v_lshlrev_b32 v92, 16, v124
    v_and_b32 v93, 0xffff0000, v124
    v_lshlrev_b32 v94, 16, v125
    v_and_b32 v95, 0xffff0000, v125
    v_pk_add_f32 v[84:85], v[84:85], v[92:93]
    v_pk_add_f32 v[86:87], v[86:87], v[94:95]
    s_waitcnt vmcnt(3)
    v_sad_u32 v148, v130, s42, v148
    v_lshlrev_b32 v92, 16, v128
    v_and_b32 v93, 0xffff0000, v128
    v_lshlrev_b32 v94, 16, v129
    v_and_b32 v95, 0xffff0000, v129
    v_pk_add_f32 v[88:89], v[88:89], v[92:93]
    v_pk_add_f32 v[90:91], v[90:91], v[94:95]
    s_waitcnt vmcnt(2)
    v_sad_u32 v148, v134, s42, v148
    v_lshlrev_b32 v92, 16, v132
    v_and_b32 v93, 0xffff0000, v132
    v_lshlrev_b32 v94, 16, v133
    v_and_b32 v95, 0xffff0000, v133
    v_pk_add_f32 v[84:85], v[84:85], v[92:93]
    v_pk_add_f32 v[86:87], v[86:87], v[94:95]
    s_waitcnt vmcnt(1)
    v_sad_u32 v148, v138, s42, v148
    v_lshlrev_b32 v92, 16, v136
    v_and_b32 v93, 0xffff0000, v136
    v_lshlrev_b32 v94, 16, v137
    v_and_b32 v95, 0xffff0000, v137
    v_pk_add_f32 v[88:89], v[88:89], v[92:93]
    v_pk_add_f32 v[90:91], v[90:91], v[94:95]
    s_waitcnt vmcnt(0)
    v_sad_u32 v148, v142, s42, v148
    v_lshlrev_b32 v92, 16, v140
    v_and_b32 v93, 0xffff0000, v140
    v_lshlrev_b32 v94, 16, v141
    v_and_b32 v95, 0xffff0000, v141
    v_pk_add_f32 v[84:85], v[84:85], v[92:93]
    v_pk_add_f32 v[86:87], v[86:87], v[94:95]
    v_cmp_ne_u32 vcc, 0, v148
    s_cbranch_vccnz L_R
L_R_x:
    s_waitcnt vmcnt(0)
    v_pk_add_f32 v[84:85], v[84:85], v[88:89]
    v_pk_add_f32 v[86:87], v[86:87], v[90:91]
    v_lshlrev_b32 v19, 16, v19
    s_nop 1
    v_permlane16_swap_b32 v84, v85
    v_permlane16_swap_b32 v86, v87
    s_nop 0
    v_add_f32 v84, v84, v85
    v_add_f32 v86, v86, v87
    s_nop 1
    v_permlane32_swap_b32 v84, v86
    s_nop 0
    v_add_f32 v84, v84, v86
    s_nop 1
    v_add_f32_dpp v84, v84, v84 row_ror:2 row_mask:0xf bank_mask:0xf
    s_nop 1
    v_add_f32_dpp v84, v84, v84 row_ror:4 row_mask:0xf bank_mask:0xf
    s_nop 1
    v_add_f32_dpp v84, v84, v84 row_ror:8 row_mask:0xf bank_mask:0xf
    v_add_f32 v84, v84, v19
    s_mov_b32 exec_lo, 0x00030003
    s_mov_b32 exec_hi, 0x00030003
    v_cvt_pk_bf16_f32 v84, v84, v84
    buffer_store_short v84, v18, s[52:55], s26 offen
    s_cmp_lg_u32 s23, 0
    s_cbranch_scc1 L_Aend
    s_mov_b64 exec, 1
    v_mov_b32 v2, s42
    v_mov_b32 v3, 0
    buffer_store_dword v2, v3, s[8:11], 0 offen sc1
    s_branch L_Aend
L_Aend0:
L_Aend:
    s_endpgm
L_Aovf:
    v_mov_b32 v241, 1
    ds_write_b32 v44, v241 offset:64
    s_branch L_Aovf_x
L_Aslow:
    v_max3_f32 v240, v156, v157, v158
    v_max_f32 v240, v240, v159
    ds_max_f32 v44, v240
    s_waitcnt lgkmcnt(0)
    s_barrier
    ds_read_b32 v240, v44
    v_mov_b32 v241, 0
    ds_write_b32 v44, v241 offset:64
    s_waitcnt lgkmcnt(0)
    v_mul_f32 v236, s56, v240
    v_fma_f32 v228, v152, s56, -v236
    v_fma_f32 v229, v153, s56, -v236
    v_fma_f32 v230, v154, s56, -v236
    v_fma_f32 v231, v155, s56, -v236
    v_fma_f32 v232, v156, s56, -v236
    v_fma_f32 v233, v157, s56, -v236
    v_fma_f32 v234, v158, s56, -v236
    v_fma_f32 v235, v159, s56, -v236
    v_exp_f32 v228, v228
    v_exp_f32 v229, v229
    v_exp_f32 v230, v230
    v_exp_f32 v231, v231
    v_exp_f32 v232, v232
    v_exp_f32 v233, v233
    v_exp_f32 v234, v234
    v_exp_f32 v235, v235
    s_nop 0
    v_cvt_pk_bf16_f32 v212, v228, v230
    v_cvt_pk_bf16_f32 v213, v229, v231
    ds_write2_b32 v40, v212, v213 offset1:2
    v_cvt_pk_bf16_f32 v214, v232, v234
    v_cvt_pk_bf16_f32 v215, v233, v235
    ds_write2_b32 v41, v214, v215 offset1:2
    s_waitcnt lgkmcnt(0)
    s_barrier
    s_branch L_Apv
L_Af1:
    s_mov_b32 s20, 0
L_Af1_l:
    s_sleep 2
    buffer_load_dword v12, v4, s[8:11], s34 offen sc1
    s_add_u32 s20, s20, 1
    s_cmp_gt_u32 s20, 20000
    s_cbranch_scc1 L_Af1_x
    s_waitcnt vmcnt(0)
    v_cmp_ne_u32 vcc, s42, v12
    s_cbranch_vccnz L_Af1_l
    s_branch L_Af1_x
L_end:
    s_endpgm
.section .rodata,"a"
.p2align 6
.amdhsa_kernel parallel_sum__compressed_kv_cla__dense_activation_silu__decode_kernel
  .amdhsa_next_free_vgpr 512
  .amdhsa_next_free_sgpr 102
  .amdhsa_accum_offset 256
  .amdhsa_group_segment_fixed_size 0
  .amdhsa_kernarg_size 96
  .amdhsa_user_sgpr_count 2
  .amdhsa_user_sgpr_kernarg_segment_ptr 1
  .amdhsa_system_sgpr_workgroup_id_x 1
.end_amdhsa_kernel
```
